```python
import torch

def _softmax(x, axis=-1):
    return torch.softmax(x, dim=axis)
def _gelu(x):
    return torch.nn.functional.gelu(x, approximate="tanh")
def _silu(x):
    return torch.nn.functional.silu(x)
def _sigmoid(x):
    return torch.sigmoid(x)
def _layernorm(x, axis=-1, eps=1e-5):
    m = x.mean(dim=axis, keepdim=True)
    v = x.var(dim=axis, keepdim=True, unbiased=False)
    return (x - m) / torch.sqrt(v + eps)
def _scatter_add(tgt, idx, src, axis=0):
    return tgt.clone().index_add_(axis, idx, src)
def _segment_sum(src, seg, n):
    out = torch.zeros((n,) + src.shape[1:], dtype=src.dtype)
    return out.index_add_(0, seg, src)
def _pad(x, pw):
    flat = tuple(v for pair in reversed(pw) for v in pair)
    return torch.nn.functional.pad(x, flat)

kernel_name = 'standalone__w8a8_smoothquant_per_tensor_per_channel_int8_activations_weights__prompt'

def setup_inputs():

    _w = (lambda a: (lambda t: t.to(torch.bfloat16) if t.is_floating_point() else t)(torch.as_tensor(a)))
    B, S, D, F = 1, 2048, 1024, 3584
    x = abs((lambda *s: torch.randn(*s, dtype=torch.bfloat16) * 0.05)(B, S, D))
    w = (lambda *s: torch.randn(*s, dtype=torch.bfloat16) * 0.05)(D, F)
    x_min, x_max = float(x.min()), float(x.max())
    sx = (x_max - x_min) / 255.0 + 1e-6
    zx = int(torch.as_tensor(-128.0 - x_min / sx).round())
    qx = torch.clamp(torch.as_tensor(x / sx).round() + zx, -128, 127).to(torch.int32)
    sw = (torch.abs(w).amax(dim=0) / 127.0 + 1e-6).to(float)
    qw = torch.clamp(torch.as_tensor(w / sw[None, :]).round(), -127, 127).to(torch.int32)
    return {
        "qx": _w(qx),
        "qw": _w(qw),
        "scale_x": _w(torch.tensor(sx, dtype=float)),
        "zero_x": _w(torch.tensor(zx, dtype=torch.int32)),
        "scale_w": _w(sw),
        "bias": _w((lambda *s: torch.randn(*s, dtype=torch.bfloat16) * 0.05)(F)),
    }

def reference(qx, qw, scale_x, zero_x, scale_w, bias):
    dt = scale_w.dtype
    acc = torch.einsum("bsd,df->bsf", (lambda x, dt: x.to(dt))(qx, dt), (lambda x, dt: x.to(dt))(qw, dt))
    w_colsum = torch.sum((lambda x, dt: x.to(dt))(qw, dt), axis=0)
    acc = acc - (lambda x, dt: x.to(dt))(zero_x, dt) * w_colsum[None, None, :]
    return acc * scale_x * scale_w[None, None, :] + bias[None, None, :]
```

```asm
; @launch grid=(256,1,1) block=(256,1,1) lds=133120
.amdgcn_target "amdgcn-amd-amdhsa--gfx950"
.text
.globl standalone__w8a8_smoothquant_per_tensor_per_channel_int8_activations_weights__prompt_kernel
.p2align 8
.type standalone__w8a8_smoothquant_per_tensor_per_channel_int8_activations_weights__prompt_kernel,@function
standalone__w8a8_smoothquant_per_tensor_per_channel_int8_activations_weights__prompt_kernel:
    s_load_dwordx4 s[4:7], s[0:1], 0
    s_load_dwordx4 s[56:59], s[0:1], 56
    s_memrealtime s[32:33]
    s_cmp_ge_u32 s2, 256
    s_cbranch_scc1 K_END
    v_lshrrev_b32 v1, 6, v0
    v_and_b32 v2, 63, v0
    v_readfirstlane_b32 s3, v1
    s_mov_b32 s14, 14680064
    s_mov_b32 s11, 0x00020000
    s_and_b32 s41, s2, 1
    s_lshl_b32 s41, s41, 3
    s_bfe_u32 s40, s2, 0x30003
    s_add_u32 s41, s41, s40
    s_bfe_u32 s40, s2, 0x20001
    s_lshl_b32 s40, s40, 2
    s_lshr_b32 s42, s2, 6
    s_add_u32 s40, s40, s42
    s_lshl_b32 s44, s40, 4
    s_add_u32 s44, s44, s41
    v_lshrrev_b32 v4, 3, v2
    v_and_b32 v7, 7, v2
    v_lshrrev_b32 v8, 4, v2
    v_mul_u32_u24 v6, 1835008, v8
    v_lshlrev_b32 v5, 12, v4
    v_lshl_add_u32 v5, v7, 4, v5
    v_and_b32 v9, 15, v2
    v_lshl_add_u32 v9, v9, 4, v6
    v_cmp_gt_u32 vcc, 128, v0
    s_and_b32 s47, s3, 1
    s_and_b32 s42, s40, 14
    s_or_b32 s42, s42, s47
    s_lshr_b32 s45, s42, 3
    s_lshl_b32 s45, s45, 7
    s_and_b32 s46, s42, 7
    s_add_u32 s45, s45, s46
    s_mul_i32 s45, s45, 57344
    s_mul_i32 s46, s41, 896
    s_add_u32 s46, s46, 128
    s_and_b32 s46, s46, 0xffffff00
    s_add_u32 s45, s45, s46
    s_and_b32 s46, s40, 1
    s_lshl_b32 s46, s46, 8
    s_add_u32 s45, s45, s46
    s_lshl_b32 s46, s44, 15
    s_lshl_b32 s47, s47, 11
    s_add_u32 s46, s46, s47
    v_cndmask_b32 v5, v9, v5, vcc
    s_mov_b32 s64, 14336
    s_mov_b32 s65, 458752
    s_cmp_lt_u32 s3, 2
    s_cselect_b32 s45, s46, s45
    s_cselect_b32 s64, 512, s64
    s_cselect_b32 s65, 128, s65
    s_cselect_b32 s10, 8388608, s14
    s_waitcnt lgkmcnt(0)
    s_cselect_b64 s[8:9], s[4:5], s[6:7]
    s_mov_b32 s51, s45
    buffer_load_dwordx4 v[16:19], v5, s[8:11], s51 offen nt
    s_add_u32 s51, s51, s64
    buffer_load_dwordx4 v[20:23], v5, s[8:11], s51 offen nt
    s_add_u32 s51, s51, s64
    buffer_load_dwordx4 v[24:27], v5, s[8:11], s51 offen nt
    s_add_u32 s51, s51, s64
    buffer_load_dwordx4 v[28:31], v5, s[8:11], s51 offen nt
    s_mul_i32 s51, s65, 1
    s_add_u32 s51, s51, s45
    buffer_load_dwordx4 v[32:35], v5, s[8:11], s51 offen nt
    s_lshr_b32 s46, s2, 3
    s_or_b32 s46, s46, s3
    s_cbranch_scc1 NOPUB
    s_or_b32 s32, s32, 1
    v_mov_b32 v12, s32
    v_mov_b32 v13, 0
    s_mov_b64 exec, 1
    global_atomic_cmpswap v13, v[12:13], s[56:57] sc1
    s_mov_b64 exec, -1
NOPUB:
    s_mov_b64 s[12:13], s[6:7]
    s_mov_b64 s[16:17], s[58:59]
    s_load_dwordx4 s[4:7], s[0:1], 16
    s_load_dwordx2 s[20:21], s[0:1], 32
    s_load_dwordx2 s[24:25], s[0:1], 40
    s_load_dwordx2 s[28:29], s[0:1], 48
    v_lshlrev_b32 v3, 4, v2
    s_getpc_b64 s[66:67]
CPF_P:
    s_add_u32 s66, s66, PAGE0-CPF_P
    s_addc_u32 s67, s67, 0
    s_bfe_u32 s55, s2, 0x30003
    s_lshl_b32 s55, s55, 2
    s_add_u32 s55, s55, s3
    s_lshl_b32 s55, s55, 9
    v_and_b32 v237, 0x1f0, v3
    v_add_u32 v237, s55, v237
    v_min_u32 v237, K_END-PAGE0+1024, v237
    global_load_dword v237, v237, s[66:67]
    s_mov_b32 s18, 8388608
    s_mov_b32 s19, 0x00020000
    s_add_u32 s52, s41, 16
    s_cmp_lt_u32 s3, 2
    s_cselect_b32 s52, s40, s52
    s_cselect_b32 s53, s41, s40
    s_mul_i32 s52, s52, 4352
    s_lshl_b32 s53, s53, 1
    s_and_b32 s33, s3, 1
    s_add_u32 s53, s53, s33
    s_lshl_b32 s53, s53, 2
    s_add_u32 s52, s52, s53
    s_add_u32 s52, s52, 7340032
    s_mul_i32 s53, s41, 4352
    s_lshl_b32 s33, s40, 2
    s_add_u32 s33, s33, s53
    s_add_u32 s33, s33, 7897088
    v_mov_b32 v232, 0
    v_cmp_gt_u32 vcc, 4, v2
    v_mul_u32_u24 v14, 139264, v2
    v_add_u32 v14, s52, v14
    v_mov_b32 v15, s33
    v_cndmask_b32 v14, v15, v14, vcc
    buffer_load_dword v236, v14, s[16:19], 0 offen sc1
    s_mul_i32 s48, s41, 233472
    s_add_u32 s48, s48, 2097152
    v_and_b32 v11, 1, v8
    v_lshrrev_b32 v10, 1, v8
    s_cmp_lt_u32 s3, 2
    s_cbranch_scc0 IFW0
    v_lshlrev_b32 v9, 8, v7
    v_lshl_add_u32 v9, v4, 4, v9
    s_lshr_b32 s47, s44, 1
    s_lshl_b32 s47, s47, 14
    s_and_b32 s49, s41, 1
    s_lshl_b32 s49, s49, 7
    s_add_u32 s47, s47, s49
    s_lshl_b32 s49, s3, 11
    s_add_u32 s47, s47, s49
    s_lshr_b32 s49, s41, 2
    s_lshl_b32 s49, s49, 12
    s_xor_b32 s47, s47, s49
    s_branch IFE0
IFW0:
    v_and_b32 v9, 15, v2
    v_lshlrev_b32 v9, 4, v9
    v_lshl_add_u32 v9, v10, 8, v9
    v_lshl_add_u32 v9, v11, 15, v9
    s_and_b32 s47, s40, 1
    s_lshl_b32 s47, s47, 16
    s_lshl_b32 s49, s42, 9
    s_add_u32 s47, s47, s49
    v_add_u32 v116, s47, v9
    s_add_u32 s47, s47, s48
IFE0:
    s_mov_b32 s54, 0x01010101
    s_waitcnt vmcnt(6)
    s_add_u32 s51, s51, s64
    buffer_load_dwordx4 v[36:39], v5, s[8:11], s51 offen nt
    s_waitcnt vmcnt(6)
    s_add_u32 s51, s51, s64
    buffer_load_dwordx4 v[40:43], v5, s[8:11], s51 offen nt
    s_waitcnt vmcnt(6)
    s_add_u32 s51, s51, s64
    buffer_load_dwordx4 v[44:47], v5, s[8:11], s51 offen nt
    s_waitcnt vmcnt(6)
    s_mul_i32 s51, s65, 2
    s_add_u32 s51, s51, s45
    buffer_load_dwordx4 v[48:51], v5, s[8:11], s51 offen nt
    s_cmp_lt_u32 s3, 2
    s_cbranch_scc0 IFW1
    v_ashr_pk_i8_i32 v12, v16, v17, 0
    v_ashr_pk_i8_i32 v13, v20, v21, 0
    v_ashr_pk_i8_i32 v14, v24, v25, 0
    v_ashr_pk_i8_i32 v15, v28, v29, 0
    v_ashr_pk_i8_i32 v12, v18, v19, 0 op_sel:[0,0,0,1]
    v_ashr_pk_i8_i32 v13, v22, v23, 0 op_sel:[0,0,0,1]
    v_ashr_pk_i8_i32 v14, v26, v27, 0 op_sel:[0,0,0,1]
    v_ashr_pk_i8_i32 v15, v30, v31, 0 op_sel:[0,0,0,1]
    buffer_store_dwordx4 v[12:15], v9, s[16:19], s47 offen sc1
    s_xor_b32 s47, s47, 4096
    s_nop 1
    s_branch IFE1
IFW1:
    v_ashr_pk_i8_i32 v12, v16, v20, 0
    v_ashr_pk_i8_i32 v13, v18, v22, 0
    v_ashr_pk_i8_i32 v14, v17, v21, 0
    v_ashr_pk_i8_i32 v15, v19, v23, 0
    v_ashr_pk_i8_i32 v12, v24, v28, 0 op_sel:[0,0,0,1]
    v_ashr_pk_i8_i32 v13, v26, v30, 0 op_sel:[0,0,0,1]
    v_ashr_pk_i8_i32 v14, v25, v29, 0 op_sel:[0,0,0,1]
    v_ashr_pk_i8_i32 v15, v27, v31, 0 op_sel:[0,0,0,1]
    s_nop 1
    v_permlane32_swap_b32 v12, v14
    v_permlane32_swap_b32 v13, v15
    s_nop 1
    v_permlane16_swap_b32 v12, v13
    v_permlane16_swap_b32 v14, v15
    buffer_store_dwordx4 v[12:15], v9, s[16:19], s47 offen sc1
    ds_write_b128 v116, v[12:15] offset:0
    s_add_u32 s47, s47, 8192
    v_dot4_i32_i8 v1, v12, s54, 0
    v_dot4_i32_i8 v1, v13, s54, v1
    v_dot4_i32_i8 v1, v14, s54, v1
    v_dot4_i32_i8 v1, v15, s54, v1
IFE1:
    s_waitcnt vmcnt(7)
    global_load_dword v235, v232, s[56:57] sc1
    s_add_u32 s51, s51, s64
    buffer_load_dwordx4 v[52:55], v5, s[8:11], s51 offen nt
    s_waitcnt lgkmcnt(0)
    s_mov_b32 s15, 0x00020000
    s_mov_b32 s22, 7168
    s_mov_b32 s23, 0x00020000
    s_mov_b32 s26, 7168
    s_mov_b32 s27, 0x00020000
    v_lshl_add_u32 v112, v11, 1, v10
    v_and_b32 v113, 15, v2
    v_lshl_add_u32 v113, v113, 2, v112
    s_lshl_b32 s55, s3, 6
    v_add_u32 v240, s55, v113
    s_and_b32 s55, s41, 1
    s_lshl_b32 s55, s55, 5
    v_add_u32 v114, s55, v240
    v_subrev_u32 v115, 224, v114
    v_min_u32 v114, v114, v115
    s_mul_i32 s55, s41, 448
    v_lshl_add_u32 v114, v114, 1, s55
    buffer_load_ushort v238, v114, s[20:23], 0 offen
    buffer_load_ushort v239, v114, s[24:27], 0 offen
    s_load_dword s34, s[4:5], 0
    s_load_dword s35, s[6:7], 0
    s_add_u32 s36, s16, s48
    s_addc_u32 s37, s17, 0
    s_mov_b32 s38, 229376
    s_mov_b32 s39, 0x00020000
    v_lshrrev_b32 v234, 2, v2
    v_lshl_add_u32 v234, v234, 2, s53
    s_cmp_eq_u32 s3, 3
    s_cselect_b32 s33, s33, 1073741824
    s_add_u32 s53, s53, 69504
    v_lshl_add_u32 v114, v2, 2, s53
    s_mul_i32 s53, s40, 4352
    v_cmp_gt_u32 vcc, 32, v2
    v_lshl_add_u32 v233, v2, 2, s53
    s_mov_b32 s53, 7340032
    v_cndmask_b32 v233, v114, v233, vcc
    s_cmp_eq_u32 s3, 3
    s_cselect_b32 s55, 1073741824, 0
    s_bfe_u32 s46, s40, 0x10002
    s_mul_i32 s46, s46, 64
    s_lshr_b32 s50, s40, 3
    s_mul_i32 s50, s50, 4
    s_add_u32 s46, s46, s50
    s_and_b32 s50, s40, 3
    s_add_u32 s46, s46, s50
    s_mul_i32 s46, s46, 114688
    s_mul_i32 s50, s41, 896
    s_add_u32 s46, s46, s50
    s_lshl_b32 s42, s3, 7
    s_add_u32 s42, s42, 512
    s_and_b32 s50, s41, 1
    s_lshl_b32 s50, s50, 7
    s_add_u32 s50, s50, s42
    s_cmp_ge_u32 s50, 896
    s_cselect_b32 s50, 0, s50
    s_add_u32 s46, s46, s50
    s_or_b32 s46, s46, s55
    v_and_b32 v114, 1, v4
    v_mul_u32_u24 v115, 57344, v114
    v_add_u32 v6, v6, v115
    v_lshl_add_u32 v6, v7, 4, v6
    v_lshlrev_b32 v10, 8, v10
    v_lshl_add_u32 v10, v114, 9, v10
    v_lshl_add_u32 v115, v7, 5, v10
    v_lshl_add_u32 v115, v11, 4, v115
    v_lshl_add_u32 v10, v7, 4, v10
    v_cmp_gt_u32 vcc, 128, v0
    v_lshl_add_u32 v10, v11, 15, v10
    s_lshl_b32 s49, s3, 7
    v_cndmask_b32 v10, v115, v10, vcc
    s_cmp_lt_u32 s3, 2
    s_cselect_b32 s49, s49, 65536
    s_add_u32 s48, s48, s49
    s_lshl_b32 s49, s40, 10
    s_add_u32 s48, s48, s49
    s_add_u32 s48, s48, 131072
    s_or_b32 s48, s48, s55
    v_lshlrev_b32 v8, 1, v113
    v_and_b32 v11, 0x3f, v8
    s_lshl_b32 s50, s41, 4
    s_add_u32 s50, s50, s40
    s_lshl_b32 s50, s50, 9
    s_add_u32 s50, s50, 6291456
    s_lshr_b32 s42, s42, 1
    s_and_b32 s49, s3, 1
    s_lshl_b32 s49, s49, 9
    s_and_b32 s55, s40, 1
    s_mul_i32 s55, s55, 384
    s_sub_u32 s49, s49, s55
    s_add_u32 s49, s49, s50
    s_cmp_lt_u32 s3, 2
    s_cselect_b32 s49, 1073741824, s49
    s_add_u32 s50, s50, s42
    s_waitcnt vmcnt(8)
    s_add_u32 s51, s51, s64
    buffer_load_dwordx4 v[56:59], v5, s[8:11], s51 offen nt
    s_waitcnt vmcnt(8)
    s_add_u32 s51, s51, s64
    buffer_load_dwordx4 v[60:63], v5, s[8:11], s51 offen nt
    s_waitcnt vmcnt(8)
    s_mul_i32 s51, s65, 3
    s_add_u32 s51, s51, s45
    buffer_load_dwordx4 v[64:67], v5, s[8:11], s51 offen nt
    s_cmp_lt_u32 s3, 2
    s_cbranch_scc0 IFW2
    v_ashr_pk_i8_i32 v12, v32, v33, 0
    v_ashr_pk_i8_i32 v13, v36, v37, 0
    v_ashr_pk_i8_i32 v14, v40, v41, 0
    v_ashr_pk_i8_i32 v15, v44, v45, 0
    v_ashr_pk_i8_i32 v12, v34, v35, 0 op_sel:[0,0,0,1]
    v_ashr_pk_i8_i32 v13, v38, v39, 0 op_sel:[0,0,0,1]
    v_ashr_pk_i8_i32 v14, v42, v43, 0 op_sel:[0,0,0,1]
    v_ashr_pk_i8_i32 v15, v46, v47, 0 op_sel:[0,0,0,1]
    buffer_store_dwordx4 v[12:15], v9, s[16:19], s47 offen sc1
    s_xor_b32 s47, s47, 12288
    s_nop 1
    s_branch IFE2
IFW2:
    v_ashr_pk_i8_i32 v12, v32, v36, 0
    v_ashr_pk_i8_i32 v13, v34, v38, 0
    v_ashr_pk_i8_i32 v14, v33, v37, 0
    v_ashr_pk_i8_i32 v15, v35, v39, 0
    v_ashr_pk_i8_i32 v12, v40, v44, 0 op_sel:[0,0,0,1]
    v_ashr_pk_i8_i32 v13, v42, v46, 0 op_sel:[0,0,0,1]
    v_ashr_pk_i8_i32 v14, v41, v45, 0 op_sel:[0,0,0,1]
    v_ashr_pk_i8_i32 v15, v43, v47, 0 op_sel:[0,0,0,1]
    s_nop 1
    v_permlane32_swap_b32 v12, v14
    v_permlane32_swap_b32 v13, v15
    s_nop 1
    v_permlane16_swap_b32 v12, v13
    v_permlane16_swap_b32 v14, v15
    buffer_store_dwordx4 v[12:15], v9, s[16:19], s47 offen sc1
    ds_write_b128 v116, v[12:15] offset:8192
    s_add_u32 s47, s47, 8192
    v_dot4_i32_i8 v1, v12, s54, v1
    v_dot4_i32_i8 v1, v13, s54, v1
    v_dot4_i32_i8 v1, v14, s54, v1
    v_dot4_i32_i8 v1, v15, s54, v1
IFE2:
    s_waitcnt vmcnt(9)
    s_add_u32 s51, s51, s64
    buffer_load_dwordx4 v[68:71], v5, s[8:11], s51 offen nt
    s_waitcnt vmcnt(7)
    v_readfirstlane_b32 s43, v235
    s_mov_b32 s55, 200000
    s_cmp_lg_u32 s43, 0
    s_cbranch_scc1 TAG_OK
TAG_RETRY:
    global_load_dword v235, v232, s[56:57] sc1
    s_sub_u32 s55, s55, 1
    s_waitcnt vmcnt(0)
    v_readfirstlane_b32 s43, v235
    s_cmp_eq_u32 s55, 0
    s_cbranch_scc1 TAG_OK
    s_cmp_eq_u32 s43, 0
    s_cbranch_scc1 TAG_RETRY
TAG_OK:
    s_mov_b64 exec, 1
    buffer_store_dword v235, v232, s[16:19], s52 offen sc1
    s_mov_b64 exec, -1
    s_add_u32 s52, s52, 139264
    s_add_u32 s51, s51, s64
    buffer_load_dwordx4 v[72:75], v5, s[8:11], s51 offen nt
    s_mov_b32 s30, 14680064
    s_mov_b32 s31, 0x00020000
    s_lshl_b32 s42, s40, 2
    s_add_u32 s42, s42, s3
    s_lshl_b32 s62, s42, 15
    s_lshl_b32 s61, s3, 12
    s_add_u32 s62, s62, s61
    s_add_u32 s63, s62, 16384
    s_lshl_b32 s60, s3, 10
    s_lshr_b32 s4, s40, 3
    s_lshl_b32 s4, s4, 1
    s_and_b32 s5, s40, 1
    s_add_u32 s55, s4, s5
    s_bfe_u32 s4, s40, 0x20001
    s_cmp_eq_u32 s4, s3
    s_cselect_b32 s55, s55, 9
    s_cmp_eq_u32 s55, 0
    s_cselect_b32 s4, 133120, s60
    s_cmp_eq_u32 s55, 1
    s_cselect_b32 s5, 133120, s60
    s_cmp_eq_u32 s55, 2
    s_cselect_b32 s6, 133120, s60
    s_cmp_eq_u32 s55, 3
    s_cselect_b32 s7, 133120, s60
    v_lshrrev_b32 v112, 4, v2
    v_and_b32 v113, 15, v2
    v_lshlrev_b32 v244, 9, v112
    v_lshl_add_u32 v244, v113, 4, v244
    v_add_u32 v245, 65536, v244
    v_mul_u32_u24 v246, 28672, v112
    v_lshl_add_u32 v247, v113, 2, v246
    v_lshl_add_u32 v246, v113, 3, v246
    s_and_b32 s55, s41, 1
    s_cselect_b32 s55, 64, 0
    v_add_u32 v246, s55, v246
    v_add_u32 v254, s55, v247
    s_cselect_b32 s55, 0, 384
    v_add_u32 v247, s55, v247
    s_mov_b32 s55, 131072
    v_lshl_add_u32 v248, v113, 2, s55
    v_lshrrev_b32 v114, 1, v113
    v_lshl_add_u32 v249, v114, 2, s55
    v_and_b32 v114, 1, v113
    v_lshl_add_u32 v249, v114, 6, v249
    v_lshl_add_u32 v250, v0, 2, s55
    v_lshlrev_b32 v251, 11, v112
    v_lshl_add_u32 v251, v113, 3, v251
    s_lshl_b32 s32, s41, 13
    s_lshl_b32 s55, s3, 7
    s_add_u32 s32, s32, s55
    s_add_u32 s32, s32, 6291456
    s_mul_i32 s68, s42, 229376
    s_mul_i32 s55, s41, 448
    s_add_u32 s68, s68, s55
    s_add_u32 s69, s68, 7168
    s_add_u32 s70, s68, 14336
    s_add_u32 s71, s68, 21504
    s_add_u32 s72, s68, 114688
    s_add_u32 s73, s68, 121856
    s_add_u32 s74, s68, 129024
    s_add_u32 s75, s68, 136192
    s_branch PAGE0
.p2align 12
PAGE0:
    s_waitcnt vmcnt(6)
    s_add_u32 s51, s51, s64
    buffer_load_dwordx4 v[76:79], v5, s[8:11], s51 offen nt
    s_waitcnt vmcnt(6)
    s_add_u32 s51, s46, 0
    buffer_load_dwordx4 v[80:83], v6, s[12:15], s51 offen nt
    s_cmp_lt_u32 s3, 2
    s_cbranch_scc0 IFW3
    v_ashr_pk_i8_i32 v12, v48, v49, 0
    v_ashr_pk_i8_i32 v13, v52, v53, 0
    v_ashr_pk_i8_i32 v14, v56, v57, 0
    v_ashr_pk_i8_i32 v15, v60, v61, 0
    v_ashr_pk_i8_i32 v12, v50, v51, 0 op_sel:[0,0,0,1]
    v_ashr_pk_i8_i32 v13, v54, v55, 0 op_sel:[0,0,0,1]
    v_ashr_pk_i8_i32 v14, v58, v59, 0 op_sel:[0,0,0,1]
    v_ashr_pk_i8_i32 v15, v62, v63, 0 op_sel:[0,0,0,1]
    buffer_store_dwordx4 v[12:15], v9, s[16:19], s47 offen sc1
    s_xor_b32 s47, s47, 4096
    s_nop 1
    s_branch IFE3
IFW3:
    v_ashr_pk_i8_i32 v12, v48, v52, 0
    v_ashr_pk_i8_i32 v13, v50, v54, 0
    v_ashr_pk_i8_i32 v14, v49, v53, 0
    v_ashr_pk_i8_i32 v15, v51, v55, 0
    v_ashr_pk_i8_i32 v12, v56, v60, 0 op_sel:[0,0,0,1]
    v_ashr_pk_i8_i32 v13, v58, v62, 0 op_sel:[0,0,0,1]
    v_ashr_pk_i8_i32 v14, v57, v61, 0 op_sel:[0,0,0,1]
    v_ashr_pk_i8_i32 v15, v59, v63, 0 op_sel:[0,0,0,1]
    s_nop 1
    v_permlane32_swap_b32 v12, v14
    v_permlane32_swap_b32 v13, v15
    s_nop 1
    v_permlane16_swap_b32 v12, v13
    v_permlane16_swap_b32 v14, v15
    buffer_store_dwordx4 v[12:15], v9, s[16:19], s47 offen sc1
    ds_write_b128 v116, v[12:15] offset:16384
    s_add_u32 s47, s47, 8192
    v_dot4_i32_i8 v1, v12, s54, v1
    v_dot4_i32_i8 v1, v13, s54, v1
    v_dot4_i32_i8 v1, v14, s54, v1
    v_dot4_i32_i8 v1, v15, s54, v1
IFE3:
    s_waitcnt vmcnt(7)
    s_add_u32 s51, s46, 14336
    buffer_load_dwordx4 v[84:87], v6, s[12:15], s51 offen nt
    s_waitcnt vmcnt(6)
    s_mov_b64 exec, 1
    buffer_store_dword v235, v232, s[16:19], s52 offen sc1
    s_mov_b64 exec, -1
    s_add_u32 s52, s52, 139264
    s_add_u32 s51, s46, 28672
    buffer_load_dwordx4 v[88:91], v6, s[12:15], s51 offen nt
    s_waitcnt vmcnt(6)
    s_add_u32 s51, s46, 43008
    buffer_load_dwordx4 v[92:95], v6, s[12:15], s51 offen nt
    s_waitcnt lgkmcnt(0)
    s_lshl_b32 s34, s34, 16
    v_cvt_f32_i32 v252, s35
    v_lshlrev_b32 v238, 16, v238
    v_lshlrev_b32 v239, 16, v239
    v_mul_f32 v238, s34, v238
    v_cvt_pk_bf16_f32 v252, v252, v252
    v_lshlrev_b32 v252, 16, v252
    v_mul_f32 v112, 0x4a800000, v238
    ds_write_b32 v250, v112
    s_mov_b32 s34, 0xcb400000
    s_cmp_lt_u32 s3, 2
    s_cselect_b32 s35, 1073741824, s32
    s_cselect_b32 s32, s32, 1073741824
    s_cselect_b32 s64, 0, s34
    s_cselect_b32 s34, s34, 0
    s_waitcnt lgkmcnt(0)
    v_mov_b32 v112, 0x40400000
    v_mov_b32 v113, 0x40400000
    v_mov_b32 v114, 0x40400000
    v_mov_b32 v115, 0x40400000
    s_mov_b64 vcc, -1
    s_branch ISL1
WARMRET:
    s_waitcnt vmcnt(6)
    s_add_u32 s51, s46, 917504
    buffer_load_dwordx4 v[96:99], v6, s[12:15], s51 offen nt
    s_cmp_lt_u32 s3, 2
    s_cbranch_scc0 IFW4
    v_ashr_pk_i8_i32 v12, v64, v65, 0
    v_ashr_pk_i8_i32 v13, v68, v69, 0
    v_ashr_pk_i8_i32 v14, v72, v73, 0
    v_ashr_pk_i8_i32 v15, v76, v77, 0
    v_ashr_pk_i8_i32 v12, v66, v67, 0 op_sel:[0,0,0,1]
    v_ashr_pk_i8_i32 v13, v70, v71, 0 op_sel:[0,0,0,1]
    v_ashr_pk_i8_i32 v14, v74, v75, 0 op_sel:[0,0,0,1]
    v_ashr_pk_i8_i32 v15, v78, v79, 0 op_sel:[0,0,0,1]
    buffer_store_dwordx4 v[12:15], v9, s[16:19], s47 offen sc1
    s_nop 1
    s_branch IFE4
IFW4:
    v_ashr_pk_i8_i32 v12, v64, v68, 0
    v_ashr_pk_i8_i32 v13, v66, v70, 0
    v_ashr_pk_i8_i32 v14, v65, v69, 0
    v_ashr_pk_i8_i32 v15, v67, v71, 0
    v_ashr_pk_i8_i32 v12, v72, v76, 0 op_sel:[0,0,0,1]
    v_ashr_pk_i8_i32 v13, v74, v78, 0 op_sel:[0,0,0,1]
    v_ashr_pk_i8_i32 v14, v73, v77, 0 op_sel:[0,0,0,1]
    v_ashr_pk_i8_i32 v15, v75, v79, 0 op_sel:[0,0,0,1]
    s_nop 1
    v_permlane32_swap_b32 v12, v14
    v_permlane32_swap_b32 v13, v15
    s_nop 1
    v_permlane16_swap_b32 v12, v13
    v_permlane16_swap_b32 v14, v15
    buffer_store_dwordx4 v[12:15], v9, s[16:19], s47 offen sc1
    ds_write_b128 v116, v[12:15] offset:24576
    s_add_u32 s47, s47, 8192
    v_dot4_i32_i8 v1, v12, s54, v1
    v_dot4_i32_i8 v1, v13, s54, v1
    v_dot4_i32_i8 v1, v14, s54, v1
    v_dot4_i32_i8 v1, v15, s54, v1
IFE4:
    s_nop 2
    buffer_store_short v1, v8, s[16:19], s49 offen sc1
    s_waitcnt vmcnt(8)
    s_add_u32 s51, s46, 931840
    buffer_load_dwordx4 v[100:103], v6, s[12:15], s51 offen nt
    buffer_load_dword v236, v233, s[16:19], s53 offen sc1
    s_waitcnt vmcnt(8)
    s_mov_b64 exec, 1
    buffer_store_dword v235, v232, s[16:19], s52 offen sc1
    s_mov_b64 exec, -1
    s_add_u32 s52, s52, 139264
    s_add_u32 s51, s46, 946176
    buffer_load_dwordx4 v[104:107], v6, s[12:15], s51 offen nt
    s_waitcnt vmcnt(8)
    s_add_u32 s51, s46, 960512
    buffer_load_dwordx4 v[108:111], v6, s[12:15], s51 offen nt
    s_waitcnt vmcnt(8)
    v_ashr_pk_i8_i32 v216, v80, v84, 0
    v_ashr_pk_i8_i32 v217, v82, v86, 0
    v_ashr_pk_i8_i32 v218, v81, v85, 0
    v_ashr_pk_i8_i32 v219, v83, v87, 0
    v_ashr_pk_i8_i32 v216, v88, v92, 0 op_sel:[0,0,0,1]
    v_ashr_pk_i8_i32 v217, v90, v94, 0 op_sel:[0,0,0,1]
    v_ashr_pk_i8_i32 v218, v89, v93, 0 op_sel:[0,0,0,1]
    v_ashr_pk_i8_i32 v219, v91, v95, 0 op_sel:[0,0,0,1]
    s_nop 1
    v_permlane32_swap_b32 v216, v218
    v_permlane32_swap_b32 v217, v219
    s_nop 1
    v_permlane16_swap_b32 v216, v217
    v_permlane16_swap_b32 v218, v219
    v_dot4_i32_i8 v1, v216, s54, 0
    v_dot4_i32_i8 v1, v217, s54, v1
    v_dot4_i32_i8 v1, v218, s54, v1
    v_dot4_i32_i8 v1, v219, s54, v1
    s_waitcnt vmcnt(7)
    s_waitcnt vmcnt(4)
    s_waitcnt vmcnt(3)
    v_cmp_ne_u32 vcc, s43, v236
    s_cbranch_vccnz PO0_SLOW
PO0_OK:
    s_cmp_eq_u32 s3, 0
    s_cselect_b32 s43, s43, 0
    s_cselect_b32 s53, s53, 1073741824
    s_add_u32 m0, s4, 0
    s_nop 0
    buffer_load_dwordx4 v3, s[36:39], m0 offen sc1 lds
    s_add_u32 m0, s4, 32768
    s_nop 0
    buffer_load_dwordx4 v3, s[36:39], m0 offen sc1 lds
    s_add_u32 m0, s5, 65536
    s_nop 0
    buffer_load_dwordx4 v3, s[36:39], m0 offen sc1 lds
    s_add_u32 m0, s5, 98304
    s_nop 0
    buffer_load_dwordx4 v3, s[36:39], m0 offen sc1 lds
    buffer_load_dwordx4 a[0:3], v3, s[16:19], s62 offen offset:0 sc1
    buffer_load_dwordx4 a[64:67], v3, s[16:19], s63 offen offset:0 sc1
    buffer_load_dwordx4 a[4:7], v3, s[16:19], s62 offen offset:1024 sc1
    buffer_load_dwordx4 a[68:71], v3, s[16:19], s63 offen offset:1024 sc1
    s_add_u32 s53, s53, 139264
    buffer_load_dword v236, v233, s[16:19], s53 offen sc1
    s_waitcnt vmcnt(10)
    s_waitcnt vmcnt(9)
    v_ashr_pk_i8_i32 v220, v96, v100, 0
    v_ashr_pk_i8_i32 v221, v98, v102, 0
    v_ashr_pk_i8_i32 v222, v97, v101, 0
    v_ashr_pk_i8_i32 v223, v99, v103, 0
    v_ashr_pk_i8_i32 v220, v104, v108, 0 op_sel:[0,0,0,1]
    v_ashr_pk_i8_i32 v221, v106, v110, 0 op_sel:[0,0,0,1]
    v_ashr_pk_i8_i32 v222, v105, v109, 0 op_sel:[0,0,0,1]
    v_ashr_pk_i8_i32 v223, v107, v111, 0 op_sel:[0,0,0,1]
    s_nop 1
    v_permlane32_swap_b32 v220, v222
    v_permlane32_swap_b32 v221, v223
    s_nop 1
    v_permlane16_swap_b32 v220, v221
    v_permlane16_swap_b32 v222, v223
    v_dot4_i32_i8 v1, v220, s54, v1
    v_dot4_i32_i8 v1, v221, s54, v1
    v_dot4_i32_i8 v1, v222, s54, v1
    v_dot4_i32_i8 v1, v223, s54, v1
    s_nop 2
    v_add_u32_dpp v1, v1, v1 row_ror:8 row_mask:0xf bank_mask:0xf
    s_add_u32 m0, s6, 4096
    s_nop 0
    buffer_load_dwordx4 v3, s[36:39], m0 offen sc1 lds
    s_add_u32 m0, s6, 36864
    s_nop 0
    buffer_load_dwordx4 v3, s[36:39], m0 offen sc1 lds
    s_add_u32 m0, s7, 69632
    s_nop 0
    buffer_load_dwordx4 v3, s[36:39], m0 offen sc1 lds
    s_add_u32 m0, s7, 102400
    s_nop 0
    buffer_load_dwordx4 v3, s[36:39], m0 offen sc1 lds
    buffer_load_dwordx4 a[8:11], v3, s[16:19], s62 offen offset:2048 sc1
    buffer_load_dwordx4 a[72:75], v3, s[16:19], s63 offen offset:2048 sc1
    buffer_load_dwordx4 a[12:15], v3, s[16:19], s62 offen offset:3072 sc1
    buffer_load_dwordx4 a[76:79], v3, s[16:19], s63 offen offset:3072 sc1
    s_getpc_b64 s[66:67]
CPF_C:
    s_bfe_u32 s55, s2, 0x30003
    s_lshl_b32 s55, s55, 2
    s_add_u32 s55, s55, s3
    s_lshl_b32 s55, s55, 9
    v_and_b32 v237, 0x1f0, v3
    v_add_u32 v237, s55, v237
    v_min_u32 v237, K_END-CPF_C+1024, v237
    global_load_dword v237, v237, s[66:67]
    s_mov_b64 exec, 1
    buffer_store_dword v235, v232, s[16:19], s52 offen sc1
    s_mov_b64 exec, -1
    s_waitcnt vmcnt(10)
    s_waitcnt lgkmcnt(0)
    v_cmp_ne_u32 vcc, s43, v236
    s_cbranch_vccnz PO1_SLOW
PO1_OK:
    s_barrier
    ds_read_b128 v[16:19], v244 offset:0
    ds_read_b128 v[20:23], v244 offset:256
    ds_read_b128 v[24:27], v244 offset:32768
    ds_read_b128 v[28:31], v244 offset:33024
    ds_read_b128 v[32:35], v245 offset:0
    ds_read_b128 v[36:39], v245 offset:256
    buffer_store_dwordx4 v[216:219], v10, s[16:19], s48 offen sc1
    s_add_u32 s48, s48, 16384
    buffer_store_dwordx4 v[220:223], v10, s[16:19], s48 offen sc1
    buffer_store_short v1, v11, s[16:19], s50 offen sc1
    s_add_u32 m0, s4, 8192
    s_nop 0
    buffer_load_dwordx4 v3, s[36:39], m0 offen sc1 lds
    s_add_u32 m0, s4, 40960
    s_nop 0
    buffer_load_dwordx4 v3, s[36:39], m0 offen sc1 lds
    s_add_u32 m0, s5, 73728
    s_nop 0
    buffer_load_dwordx4 v3, s[36:39], m0 offen sc1 lds
    ds_read_b128 v[40:43], v245 offset:32768
    s_waitcnt lgkmcnt(3)
    v_mfma_i32_16x16x64_i8 v[120:123], a[0:3], v[16:19], v[112:115]
    s_add_u32 m0, s5, 106496
    v_mfma_i32_16x16x64_i8 v[128:131], a[64:67], v[16:19], v[112:115]
    ds_read_b128 v[44:47], v245 offset:33024
    v_mfma_i32_16x16x64_i8 v[124:127], a[0:3], v[20:23], v[112:115]
    buffer_load_dwordx4 v3, s[36:39], m0 offen sc1 lds
    v_mfma_i32_16x16x64_i8 v[132:135], a[64:67], v[20:23], v[112:115]
    ds_read_b128 v[48:51], v244 offset:2048
    s_add_u32 s53, s53, 139264
    buffer_load_dword v236, v233, s[16:19], s53 offen sc1
    v_mfma_i32_16x16x64_i8 v[136:139], a[0:3], v[24:27], v[112:115]
    s_xor_b32 s62, s62, 4096
    v_mfma_i32_16x16x64_i8 v[144:147], a[64:67], v[24:27], v[112:115]
    ds_read_b128 v[52:55], v244 offset:2304
    v_mfma_i32_16x16x64_i8 v[140:143], a[0:3], v[28:31], v[112:115]
    buffer_load_dwordx4 a[16:19], v3, s[16:19], s62 offen offset:0 sc1
    v_mfma_i32_16x16x64_i8 v[148:151], a[64:67], v[28:31], v[112:115]
    ds_read_b128 v[56:59], v244 offset:34816
    s_waitcnt lgkmcnt(3)
    v_mfma_i32_16x16x64_i8 v[152:155], a[0:3], v[32:35], v[112:115]
    s_xor_b32 s63, s63, 4096
    v_mfma_i32_16x16x64_i8 v[160:163], a[64:67], v[32:35], v[112:115]
    ds_read_b128 v[60:63], v244 offset:35072
    v_mfma_i32_16x16x64_i8 v[156:159], a[0:3], v[36:39], v[112:115]
    buffer_load_dwordx4 a[80:83], v3, s[16:19], s63 offen offset:0 sc1
    v_mfma_i32_16x16x64_i8 v[164:167], a[64:67], v[36:39], v[112:115]
    ds_read_b128 v[16:19], v245 offset:2048
    v_mfma_i32_16x16x64_i8 v[168:171], a[0:3], v[40:43], v[112:115]
    v_mfma_i32_16x16x64_i8 v[176:179], a[64:67], v[40:43], v[112:115]
    ds_read_b128 v[20:23], v245 offset:2304
    v_mfma_i32_16x16x64_i8 v[172:175], a[0:3], v[44:47], v[112:115]
    buffer_load_dwordx4 a[20:23], v3, s[16:19], s62 offen offset:1024 sc1
    v_mfma_i32_16x16x64_i8 v[180:183], a[64:67], v[44:47], v[112:115]
    ds_read_b128 v[24:27], v245 offset:34816
    s_waitcnt lgkmcnt(3)
    v_mfma_i32_16x16x64_i8 v[120:123], a[4:7], v[48:51], v[120:123]
    v_mfma_i32_16x16x64_i8 v[128:131], a[68:71], v[48:51], v[128:131]
    ds_read_b128 v[28:31], v245 offset:35072
    v_mfma_i32_16x16x64_i8 v[124:127], a[4:7], v[52:55], v[124:127]
    buffer_load_dwordx4 a[84:87], v3, s[16:19], s63 offen offset:1024 sc1
    v_mfma_i32_16x16x64_i8 v[132:135], a[68:71], v[52:55], v[132:135]
    s_waitcnt vmcnt(18)
    s_barrier
    ds_read_b128 v[32:35], v244 offset:4096
    v_mfma_i32_16x16x64_i8 v[136:139], a[4:7], v[56:59], v[136:139]
    s_add_u32 m0, s6, 12288
    v_mfma_i32_16x16x64_i8 v[144:147], a[68:71], v[56:59], v[144:147]
    ds_read_b128 v[36:39], v244 offset:4352
    v_mfma_i32_16x16x64_i8 v[140:143], a[4:7], v[60:63], v[140:143]
    buffer_load_dwordx4 v3, s[36:39], m0 offen sc1 lds
    v_mfma_i32_16x16x64_i8 v[148:151], a[68:71], v[60:63], v[148:151]
    ds_read_b128 v[40:43], v244 offset:36864
    s_waitcnt lgkmcnt(3)
    v_mfma_i32_16x16x64_i8 v[152:155], a[4:7], v[16:19], v[152:155]
    s_add_u32 m0, s6, 45056
    v_mfma_i32_16x16x64_i8 v[160:163], a[68:71], v[16:19], v[160:163]
    ds_read_b128 v[44:47], v244 offset:37120
    v_mfma_i32_16x16x64_i8 v[156:159], a[4:7], v[20:23], v[156:159]
    buffer_load_dwordx4 v3, s[36:39], m0 offen sc1 lds
    v_mfma_i32_16x16x64_i8 v[164:167], a[68:71], v[20:23], v[164:167]
    ds_read_b128 v[48:51], v245 offset:4096
    s_add_u32 m0, s7, 77824
    v_mfma_i32_16x16x64_i8 v[168:171], a[4:7], v[24:27], v[168:171]
    v_mfma_i32_16x16x64_i8 v[176:179], a[68:71], v[24:27], v[176:179]
    ds_read_b128 v[52:55], v245 offset:4352
    v_mfma_i32_16x16x64_i8 v[172:175], a[4:7], v[28:31], v[172:175]
    buffer_load_dwordx4 v3, s[36:39], m0 offen sc1 lds
    v_mfma_i32_16x16x64_i8 v[180:183], a[68:71], v[28:31], v[180:183]
    ds_read_b128 v[56:59], v245 offset:36864
    s_waitcnt vmcnt(19) lgkmcnt(3)
    v_mfma_i32_16x16x64_i8 v[120:123], a[8:11], v[32:35], v[120:123]
    s_add_u32 m0, s7, 110592
    v_mfma_i32_16x16x64_i8 v[128:131], a[72:75], v[32:35], v[128:131]
    ds_read_b128 v[60:63], v245 offset:37120
    v_mfma_i32_16x16x64_i8 v[124:127], a[8:11], v[36:39], v[124:127]
    buffer_load_dwordx4 v3, s[36:39], m0 offen sc1 lds
    v_mfma_i32_16x16x64_i8 v[132:135], a[72:75], v[36:39], v[132:135]
    ds_read_b128 v[16:19], v244 offset:6144
    v_mfma_i32_16x16x64_i8 v[136:139], a[8:11], v[40:43], v[136:139]
    v_mfma_i32_16x16x64_i8 v[144:147], a[72:75], v[40:43], v[144:147]
    ds_read_b128 v[20:23], v244 offset:6400
    v_mfma_i32_16x16x64_i8 v[140:143], a[8:11], v[44:47], v[140:143]
    buffer_load_dwordx4 a[24:27], v3, s[16:19], s62 offen offset:2048 sc1
    v_mfma_i32_16x16x64_i8 v[148:151], a[72:75], v[44:47], v[148:151]
    ds_read_b128 v[24:27], v244 offset:38912
    s_waitcnt lgkmcnt(3)
    v_mfma_i32_16x16x64_i8 v[152:155], a[8:11], v[48:51], v[152:155]
    v_mfma_i32_16x16x64_i8 v[160:163], a[72:75], v[48:51], v[160:163]
    ds_read_b128 v[28:31], v244 offset:39168
    v_mfma_i32_16x16x64_i8 v[156:159], a[8:11], v[52:55], v[156:159]
    buffer_load_dwordx4 a[88:91], v3, s[16:19], s63 offen offset:2048 sc1
    v_mfma_i32_16x16x64_i8 v[164:167], a[72:75], v[52:55], v[164:167]
    ds_read_b128 v[32:35], v245 offset:6144
    v_mfma_i32_16x16x64_i8 v[168:171], a[8:11], v[56:59], v[168:171]
    v_mfma_i32_16x16x64_i8 v[176:179], a[72:75], v[56:59], v[176:179]
    ds_read_b128 v[36:39], v245 offset:6400
    v_mfma_i32_16x16x64_i8 v[172:175], a[8:11], v[60:63], v[172:175]
    buffer_load_dwordx4 a[28:31], v3, s[16:19], s62 offen offset:3072 sc1
    v_mfma_i32_16x16x64_i8 v[180:183], a[72:75], v[60:63], v[180:183]
    ds_read_b128 v[40:43], v245 offset:38912
    s_waitcnt vmcnt(21) lgkmcnt(3)
    v_mfma_i32_16x16x64_i8 v[120:123], a[12:15], v[16:19], v[120:123]
    ds_read2_b32 v[64:65], v248 offset0:0 offset1:32
    ds_read2_b32 v[68:69], v248 offset0:16 offset1:48
    v_mfma_i32_16x16x64_i8 v[128:131], a[76:79], v[16:19], v[128:131]
    ds_read_b128 v[44:47], v245 offset:39168
    ds_read2_b32 v[72:73], v248 offset0:64 offset1:96
    v_mfma_i32_16x16x64_i8 v[124:127], a[12:15], v[20:23], v[124:127]
    buffer_load_dwordx4 a[92:95], v3, s[16:19], s63 offen offset:3072 sc1
    v_mfma_i32_16x16x64_i8 v[132:135], a[76:79], v[20:23], v[132:135]
    s_waitcnt vmcnt(12)
    v_cmp_ne_u32 vcc, s43, v236
    s_cbranch_vccnz PO2_SLOW
PO2_OK:
    s_barrier
    s_mov_b64 exec, 1
    buffer_store_dword v235, v232, s[16:19], s33 offen sc1
    s_mov_b64 exec, -1
    ds_read_b128 v[48:51], v244 offset:8192
    v_mfma_i32_16x16x64_i8 v[136:139], a[12:15], v[24:27], v[136:139]
    s_add_u32 m0, s4, 16384
    ds_read2_b32 v[76:77], v248 offset0:80 offset1:112
    v_mfma_i32_16x16x64_i8 v[144:147], a[76:79], v[24:27], v[144:147]
    ds_read_b128 v[52:55], v244 offset:8448
    ds_read2_b32 v[80:81], v248 offset0:128 offset1:160
    v_mfma_i32_16x16x64_i8 v[140:143], a[12:15], v[28:31], v[140:143]
    buffer_load_dwordx4 v3, s[36:39], m0 offen sc1 lds
    v_mfma_i32_16x16x64_i8 v[148:151], a[76:79], v[28:31], v[148:151]
    ds_read_b128 v[56:59], v244 offset:40960
    s_waitcnt lgkmcnt(6)
    v_mfma_i32_16x16x64_i8 v[152:155], a[12:15], v[32:35], v[152:155]
    s_add_u32 m0, s4, 49152
    ds_read2_b32 v[84:85], v248 offset0:144 offset1:176
    v_mfma_i32_16x16x64_i8 v[160:163], a[76:79], v[32:35], v[160:163]
    ds_read_b128 v[60:63], v244 offset:41216
    ds_read2_b32 v[88:89], v249 offset0:192 offset1:224
    v_mfma_i32_16x16x64_i8 v[156:159], a[12:15], v[36:39], v[156:159]
    buffer_load_dwordx4 v3, s[36:39], m0 offen sc1 lds
    v_mfma_i32_16x16x64_i8 v[164:167], a[76:79], v[36:39], v[164:167]
    ds_read_b128 v[16:19], v245 offset:8192
    s_add_u32 m0, s5, 81920
    v_mfma_i32_16x16x64_i8 v[168:171], a[12:15], v[40:43], v[168:171]
    v_add_u32 v248, 1024, v248
    v_add_u32 v249, 1024, v249
    v_mfma_i32_16x16x64_i8 v[176:179], a[76:79], v[40:43], v[176:179]
    ds_read_b128 v[20:23], v245 offset:8448
    v_mfma_i32_16x16x64_i8 v[172:175], a[12:15], v[44:47], v[172:175]
    buffer_load_dwordx4 v3, s[36:39], m0 offen sc1 lds
    v_mfma_i32_16x16x64_i8 v[180:183], a[76:79], v[44:47], v[180:183]
    ds_read_b128 v[24:27], v245 offset:40960
    s_waitcnt vmcnt(14) lgkmcnt(4)
    v_mfma_i32_16x16x64_i8 v[120:123], a[16:19], v[48:51], v[120:123]
    s_add_u32 m0, s5, 114688
    v_mfma_i32_16x16x64_i8 v[128:131], a[80:83], v[48:51], v[128:131]
    ds_read_b128 v[28:31], v245 offset:41216
    v_mfma_i32_16x16x64_i8 v[124:127], a[16:19], v[52:55], v[124:127]
    buffer_load_dwordx4 v3, s[36:39], m0 offen sc1 lds
    v_mfma_i32_16x16x64_i8 v[132:135], a[80:83], v[52:55], v[132:135]
    ds_read_b128 v[32:35], v244 offset:10240
    s_add_u32 s53, s53, 139264
    buffer_load_dword v236, v233, s[16:19], s53 offen sc1
    v_mfma_i32_16x16x64_i8 v[136:139], a[16:19], v[56:59], v[136:139]
    s_xor_b32 s62, s62, 12288
    v_mfma_i32_16x16x64_i8 v[144:147], a[80:83], v[56:59], v[144:147]
    ds_read_b128 v[36:39], v244 offset:10496
    v_mfma_i32_16x16x64_i8 v[140:143], a[16:19], v[60:63], v[140:143]
    buffer_load_dwordx4 a[32:35], v3, s[16:19], s62 offen offset:0 sc1
    v_mfma_i32_16x16x64_i8 v[148:151], a[80:83], v[60:63], v[148:151]
    ds_read_b128 v[40:43], v244 offset:43008
    s_waitcnt lgkmcnt(3)
    v_mfma_i32_16x16x64_i8 v[152:155], a[16:19], v[16:19], v[152:155]
    s_xor_b32 s63, s63, 12288
    v_mfma_i32_16x16x64_i8 v[160:163], a[80:83], v[16:19], v[160:163]
    ds_read_b128 v[44:47], v244 offset:43264
    v_mfma_i32_16x16x64_i8 v[156:159], a[16:19], v[20:23], v[156:159]
    buffer_load_dwordx4 a[96:99], v3, s[16:19], s63 offen offset:0 sc1
    v_mfma_i32_16x16x64_i8 v[164:167], a[80:83], v[20:23], v[164:167]
    ds_read_b128 v[48:51], v245 offset:10240
    v_mfma_i32_16x16x64_i8 v[168:171], a[16:19], v[24:27], v[168:171]
    v_mfma_i32_16x16x64_i8 v[176:179], a[80:83], v[24:27], v[176:179]
    ds_read_b128 v[52:55], v245 offset:10496
    v_mfma_i32_16x16x64_i8 v[172:175], a[16:19], v[28:31], v[172:175]
    buffer_load_dwordx4 a[36:39], v3, s[16:19], s62 offen offset:1024 sc1
    v_mfma_i32_16x16x64_i8 v[180:183], a[80:83], v[28:31], v[180:183]
    ds_read_b128 v[56:59], v245 offset:43008
    s_waitcnt vmcnt(17) lgkmcnt(3)
    v_mfma_i32_16x16x64_i8 v[120:123], a[20:23], v[32:35], v[120:123]
    v_mfma_i32_16x16x64_i8 v[128:131], a[84:87], v[32:35], v[128:131]
    ds_read_b128 v[60:63], v245 offset:43264
    v_mfma_i32_16x16x64_i8 v[124:127], a[20:23], v[36:39], v[124:127]
    buffer_load_dwordx4 a[100:103], v3, s[16:19], s63 offen offset:1024 sc1
    v_mfma_i32_16x16x64_i8 v[132:135], a[84:87], v[36:39], v[132:135]
    s_waitcnt vmcnt(14)
    s_barrier
    ds_read_b128 v[16:19], v244 offset:12288
    v_mfma_i32_16x16x64_i8 v[136:139], a[20:23], v[40:43], v[136:139]
    s_add_u32 m0, s6, 20480
    v_mfma_i32_16x16x64_i8 v[144:147], a[84:87], v[40:43], v[144:147]
    ds_read_b128 v[20:23], v244 offset:12544
    v_mfma_i32_16x16x64_i8 v[140:143], a[20:23], v[44:47], v[140:143]
    buffer_load_dwordx4 v3, s[36:39], m0 offen sc1 lds
    v_mfma_i32_16x16x64_i8 v[148:151], a[84:87], v[44:47], v[148:151]
    ds_read_b128 v[24:27], v244 offset:45056
    s_waitcnt lgkmcnt(3)
    v_mfma_i32_16x16x64_i8 v[152:155], a[20:23], v[48:51], v[152:155]
    s_add_u32 m0, s6, 53248
    v_mfma_i32_16x16x64_i8 v[160:163], a[84:87], v[48:51], v[160:163]
    ds_read_b128 v[28:31], v244 offset:45312
    v_mfma_i32_16x16x64_i8 v[156:159], a[20:23], v[52:55], v[156:159]
    buffer_load_dwordx4 v3, s[36:39], m0 offen sc1 lds
    v_mfma_i32_16x16x64_i8 v[164:167], a[84:87], v[52:55], v[164:167]
    ds_read_b128 v[32:35], v245 offset:12288
    s_add_u32 m0, s7, 86016
    v_mfma_i32_16x16x64_i8 v[168:171], a[20:23], v[56:59], v[168:171]
    v_mfma_i32_16x16x64_i8 v[176:179], a[84:87], v[56:59], v[176:179]
    ds_read_b128 v[36:39], v245 offset:12544
    v_mfma_i32_16x16x64_i8 v[172:175], a[20:23], v[60:63], v[172:175]
    buffer_load_dwordx4 v3, s[36:39], m0 offen sc1 lds
    v_mfma_i32_16x16x64_i8 v[180:183], a[84:87], v[60:63], v[180:183]
    ds_read_b128 v[40:43], v245 offset:45056
    s_waitcnt vmcnt(15) lgkmcnt(3)
    v_mfma_i32_16x16x64_i8 v[120:123], a[24:27], v[16:19], v[120:123]
    s_add_u32 m0, s7, 118784
    v_mfma_i32_16x16x64_i8 v[128:131], a[88:91], v[16:19], v[128:131]
    ds_read_b128 v[44:47], v245 offset:45312
    v_mfma_i32_16x16x64_i8 v[124:127], a[24:27], v[20:23], v[124:127]
    buffer_load_dwordx4 v3, s[36:39], m0 offen sc1 lds
    v_mfma_i32_16x16x64_i8 v[132:135], a[88:91], v[20:23], v[132:135]
    ds_read_b128 v[48:51], v244 offset:14336
    v_mfma_i32_16x16x64_i8 v[136:139], a[24:27], v[24:27], v[136:139]
    v_mfma_i32_16x16x64_i8 v[144:147], a[88:91], v[24:27], v[144:147]
    ds_read_b128 v[52:55], v244 offset:14592
    v_mfma_i32_16x16x64_i8 v[140:143], a[24:27], v[28:31], v[140:143]
    buffer_load_dwordx4 a[40:43], v3, s[16:19], s62 offen offset:2048 sc1
    v_mfma_i32_16x16x64_i8 v[148:151], a[88:91], v[28:31], v[148:151]
    ds_read_b128 v[56:59], v244 offset:47104
    s_waitcnt lgkmcnt(3)
    v_mfma_i32_16x16x64_i8 v[152:155], a[24:27], v[32:35], v[152:155]
    v_mfma_i32_16x16x64_i8 v[160:163], a[88:91], v[32:35], v[160:163]
    ds_read_b128 v[60:63], v244 offset:47360
    v_mfma_i32_16x16x64_i8 v[156:159], a[24:27], v[36:39], v[156:159]
    buffer_load_dwordx4 a[104:107], v3, s[16:19], s63 offen offset:2048 sc1
    v_mfma_i32_16x16x64_i8 v[164:167], a[88:91], v[36:39], v[164:167]
    ds_read_b128 v[16:19], v245 offset:14336
    v_mfma_i32_16x16x64_i8 v[168:171], a[24:27], v[40:43], v[168:171]
    v_mfma_i32_16x16x64_i8 v[176:179], a[88:91], v[40:43], v[176:179]
    ds_read_b128 v[20:23], v245 offset:14592
    v_mfma_i32_16x16x64_i8 v[172:175], a[24:27], v[44:47], v[172:175]
    buffer_load_dwordx4 a[44:47], v3, s[16:19], s62 offen offset:3072 sc1
    v_mfma_i32_16x16x64_i8 v[180:183], a[88:91], v[44:47], v[180:183]
    ds_read_b128 v[24:27], v245 offset:47104
    s_waitcnt vmcnt(17) lgkmcnt(3)
    v_mfma_i32_16x16x64_i8 v[120:123], a[28:31], v[48:51], v[120:123]
    v_mfma_i32_16x16x64_i8 v[128:131], a[92:95], v[48:51], v[128:131]
    ds_read_b128 v[28:31], v245 offset:47360
    v_mfma_i32_16x16x64_i8 v[124:127], a[28:31], v[52:55], v[124:127]
    buffer_load_dwordx4 a[108:111], v3, s[16:19], s63 offen offset:3072 sc1
    v_mfma_i32_16x16x64_i8 v[132:135], a[92:95], v[52:55], v[132:135]
    s_waitcnt vmcnt(12)
    v_cmp_ne_u32 vcc, s43, v236
    s_cbranch_vccnz PO3_SLOW
PO3_OK:
    s_barrier
    ds_read_b128 v[32:35], v244 offset:16384
    v_mfma_i32_16x16x64_i8 v[136:139], a[28:31], v[56:59], v[136:139]
    buffer_load_dwordx2 v[96:97], v251, s[16:19], s32 offen offset:0 sc1
    v_mfma_i32_16x16x64_i8 v[144:147], a[92:95], v[56:59], v[144:147]
    ds_read_b128 v[36:39], v244 offset:16640
    v_mfma_i32_16x16x64_i8 v[140:143], a[28:31], v[60:63], v[140:143]
    buffer_load_dwordx2 v[98:99], v251, s[16:19], s32 offen offset:512 sc1
    v_mfma_i32_16x16x64_i8 v[148:151], a[92:95], v[60:63], v[148:151]
    ds_read_b128 v[40:43], v244 offset:49152
    s_waitcnt lgkmcnt(3)
    v_mfma_i32_16x16x64_i8 v[152:155], a[28:31], v[16:19], v[152:155]
    buffer_load_dwordx2 v[100:101], v251, s[16:19], s32 offen offset:1024 sc1
    v_mfma_i32_16x16x64_i8 v[160:163], a[92:95], v[16:19], v[160:163]
    ds_read_b128 v[44:47], v244 offset:49408
    v_mfma_i32_16x16x64_i8 v[156:159], a[28:31], v[20:23], v[156:159]
    buffer_load_dwordx2 v[102:103], v251, s[16:19], s32 offen offset:1536 sc1
    v_mfma_i32_16x16x64_i8 v[164:167], a[92:95], v[20:23], v[164:167]
    ds_read_b128 v[48:51], v245 offset:16384
    s_add_u32 m0, s4, 24576
    v_mfma_i32_16x16x64_i8 v[168:171], a[28:31], v[24:27], v[168:171]
    buffer_load_dwordx4 v3, s[36:39], m0 offen sc1 lds
    v_mfma_i32_16x16x64_i8 v[176:179], a[92:95], v[24:27], v[176:179]
    ds_read_b128 v[52:55], v245 offset:16640
    s_add_u32 m0, s4, 57344
    v_mfma_i32_16x16x64_i8 v[172:175], a[28:31], v[28:31], v[172:175]
    v_mfma_i32_16x16x64_i8 v[180:183], a[92:95], v[28:31], v[180:183]
    ds_read_b128 v[56:59], v245 offset:49152
    s_waitcnt vmcnt(15) lgkmcnt(3)
    v_mfma_i32_16x16x64_i8 v[120:123], a[32:35], v[32:35], v[120:123]
    buffer_load_dwordx4 v3, s[36:39], m0 offen sc1 lds
    v_mfma_i32_16x16x64_i8 v[128:131], a[96:99], v[32:35], v[128:131]
    ds_read_b128 v[60:63], v245 offset:49408
    s_add_u32 s53, s53, 139264
    buffer_load_dword v236, v234, s[16:19], s53 offen sc1
    v_mfma_i32_16x16x64_i8 v[124:127], a[32:35], v[36:39], v[124:127]
    s_xor_b32 s62, s62, 4096
    v_mfma_i32_16x16x64_i8 v[132:135], a[96:99], v[36:39], v[132:135]
    ds_read_b128 v[16:19], v244 offset:18432
    v_mfma_i32_16x16x64_i8 v[136:139], a[32:35], v[40:43], v[136:139]
    buffer_load_dwordx4 a[48:51], v3, s[16:19], s62 offen offset:0 sc1
    v_mfma_i32_16x16x64_i8 v[144:147], a[96:99], v[40:43], v[144:147]
    ds_read_b128 v[20:23], v244 offset:18688
    s_xor_b32 s63, s63, 4096
    v_mfma_i32_16x16x64_i8 v[140:143], a[32:35], v[44:47], v[140:143]
    v_mfma_i32_16x16x64_i8 v[148:151], a[96:99], v[44:47], v[148:151]
    ds_read_b128 v[24:27], v244 offset:51200
    s_waitcnt lgkmcnt(3)
    v_mfma_i32_16x16x64_i8 v[152:155], a[32:35], v[48:51], v[152:155]
    buffer_load_dwordx4 a[112:115], v3, s[16:19], s63 offen offset:0 sc1
    v_mfma_i32_16x16x64_i8 v[160:163], a[96:99], v[48:51], v[160:163]
    ds_read_b128 v[28:31], v244 offset:51456
    v_mfma_i32_16x16x64_i8 v[156:159], a[32:35], v[52:55], v[156:159]
    v_mfma_i32_16x16x64_i8 v[164:167], a[96:99], v[52:55], v[164:167]
    ds_read_b128 v[32:35], v245 offset:18432
    v_mfma_i32_16x16x64_i8 v[168:171], a[32:35], v[56:59], v[168:171]
    buffer_load_dwordx4 a[52:55], v3, s[16:19], s62 offen offset:1024 sc1
    v_mfma_i32_16x16x64_i8 v[176:179], a[96:99], v[56:59], v[176:179]
    ds_read_b128 v[36:39], v245 offset:18688
    v_mfma_i32_16x16x64_i8 v[172:175], a[32:35], v[60:63], v[172:175]
    v_mfma_i32_16x16x64_i8 v[180:183], a[96:99], v[60:63], v[180:183]
    ds_read_b128 v[40:43], v245 offset:51200
    s_waitcnt vmcnt(18) lgkmcnt(3)
    v_mfma_i32_16x16x64_i8 v[120:123], a[36:39], v[16:19], v[120:123]
    buffer_load_dwordx4 a[116:119], v3, s[16:19], s63 offen offset:1024 sc1
    v_mfma_i32_16x16x64_i8 v[128:131], a[100:103], v[16:19], v[128:131]
    ds_read_b128 v[44:47], v245 offset:51456
ISL1:
    s_cbranch_vccnz ISL2
    s_add_u32 m0, s6, 28672
    v_mfma_i32_16x16x64_i8 v[124:127], a[36:39], v[20:23], v[124:127]
    v_mfma_i32_16x16x64_i8 v[132:135], a[100:103], v[20:23], v[132:135]
    s_waitcnt vmcnt(15)
    s_barrier
    ds_read_b128 v[48:51], v244 offset:20480
    v_mfma_i32_16x16x64_i8 v[136:139], a[36:39], v[24:27], v[136:139]
    buffer_load_dwordx4 v3, s[36:39], m0 offen sc1 lds
    v_mfma_i32_16x16x64_i8 v[144:147], a[100:103], v[24:27], v[144:147]
    ds_read_b128 v[52:55], v244 offset:20736
    s_add_u32 m0, s6, 61440
    v_mfma_i32_16x16x64_i8 v[140:143], a[36:39], v[28:31], v[140:143]
    buffer_load_dwordx4 v3, s[36:39], m0 offen sc1 lds
    v_mfma_i32_16x16x64_i8 v[148:151], a[100:103], v[28:31], v[148:151]
    ds_read_b128 v[56:59], v244 offset:53248
    s_waitcnt lgkmcnt(3)
    v_mfma_i32_16x16x64_i8 v[152:155], a[36:39], v[32:35], v[152:155]
    s_add_u32 m0, s5, 90112
    v_mfma_i32_16x16x64_i8 v[160:163], a[100:103], v[32:35], v[160:163]
    ds_read_b128 v[60:63], v244 offset:53504
    v_mfma_i32_16x16x64_i8 v[156:159], a[36:39], v[36:39], v[156:159]
    buffer_load_dwordx4 v3, s[36:39], m0 offen sc1 lds
    v_mfma_i32_16x16x64_i8 v[164:167], a[100:103], v[36:39], v[164:167]
    ds_read_b128 v[16:19], v245 offset:20480
    s_add_u32 m0, s5, 122880
    v_mfma_i32_16x16x64_i8 v[168:171], a[36:39], v[40:43], v[168:171]
    v_mfma_i32_16x16x64_i8 v[176:179], a[100:103], v[40:43], v[176:179]
    ds_read_b128 v[20:23], v245 offset:20736
    v_mfma_i32_16x16x64_i8 v[172:175], a[36:39], v[44:47], v[172:175]
    buffer_load_dwordx4 v3, s[36:39], m0 offen sc1 lds
    v_mfma_i32_16x16x64_i8 v[180:183], a[100:103], v[44:47], v[180:183]
    ds_read_b128 v[24:27], v245 offset:53248
    s_waitcnt vmcnt(17) lgkmcnt(3)
    v_mfma_i32_16x16x64_i8 v[120:123], a[40:43], v[48:51], v[120:123]
    s_waitcnt vmcnt(11)
    v_pk_add_i16 v96, v96, v100
    v_mfma_i32_16x16x64_i8 v[128:131], a[104:107], v[48:51], v[128:131]
    ds_read_b128 v[28:31], v245 offset:53504
    v_pk_add_i16 v97, v97, v101
    v_mfma_i32_16x16x64_i8 v[124:127], a[40:43], v[52:55], v[124:127]
    buffer_load_dwordx4 a[56:59], v3, s[16:19], s62 offen offset:2048 sc1
    v_mfma_i32_16x16x64_i8 v[132:135], a[104:107], v[52:55], v[132:135]
    ds_read_b128 v[32:35], v244 offset:22528
    v_pk_add_i16 v98, v98, v102
    v_mfma_i32_16x16x64_i8 v[136:139], a[40:43], v[56:59], v[136:139]
    buffer_load_dwordx4 a[120:123], v3, s[16:19], s63 offen offset:2048 sc1
    v_mfma_i32_16x16x64_i8 v[144:147], a[104:107], v[56:59], v[144:147]
    ds_read_b128 v[36:39], v244 offset:22784
    v_pk_add_i16 v99, v99, v103
    v_mfma_i32_16x16x64_i8 v[140:143], a[40:43], v[60:63], v[140:143]
    buffer_load_dwordx4 a[60:63], v3, s[16:19], s62 offen offset:3072 sc1
    v_mfma_i32_16x16x64_i8 v[148:151], a[104:107], v[60:63], v[148:151]
    ds_read_b128 v[40:43], v244 offset:55296
    s_waitcnt lgkmcnt(3)
    v_mfma_i32_16x16x64_i8 v[152:155], a[40:43], v[16:19], v[152:155]
    buffer_load_dwordx4 a[124:127], v3, s[16:19], s63 offen offset:3072 sc1
    v_mfma_i32_16x16x64_i8 v[160:163], a[104:107], v[16:19], v[160:163]
    ds_read_b128 v[44:47], v244 offset:55552
    s_add_u32 m0, s7, 94208
    v_mfma_i32_16x16x64_i8 v[156:159], a[40:43], v[20:23], v[156:159]
    v_pk_add_i16 v96, v96, v98
    v_pk_add_i16 v97, v97, v99
    v_mfma_i32_16x16x64_i8 v[164:167], a[104:107], v[20:23], v[164:167]
    ds_read_b128 v[48:51], v245 offset:22528
    v_bfe_i32 v92, v96, 0, 16
    v_mfma_i32_16x16x64_i8 v[168:171], a[40:43], v[24:27], v[168:171]
    buffer_load_dwordx4 v3, s[36:39], m0 offen sc1 lds
    v_mfma_i32_16x16x64_i8 v[176:179], a[104:107], v[24:27], v[176:179]
    ds_read_b128 v[52:55], v245 offset:22784
    s_add_u32 m0, s7, 126976
    v_mfma_i32_16x16x64_i8 v[172:175], a[40:43], v[28:31], v[172:175]
    v_ashrrev_i32 v93, 16, v96
    v_bfe_i32 v94, v97, 0, 16
    v_mfma_i32_16x16x64_i8 v[180:183], a[104:107], v[28:31], v[180:183]
    ds_read_b128 v[56:59], v245 offset:55296
    s_waitcnt lgkmcnt(3)
    v_mfma_i32_16x16x64_i8 v[120:123], a[44:47], v[32:35], v[120:123]
    buffer_load_dwordx4 v3, s[36:39], m0 offen sc1 lds
    v_mfma_i32_16x16x64_i8 v[128:131], a[108:111], v[32:35], v[128:131]
    ds_read_b128 v[60:63], v245 offset:55552
    v_ashrrev_i32 v95, 16, v97
    v_mfma_i32_16x16x64_i8 v[124:127], a[44:47], v[36:39], v[124:127]
    v_permlane32_swap_b32 v92, v93
    s_nop 0
    v_mfma_i32_16x16x64_i8 v[132:135], a[108:111], v[36:39], v[132:135]
    s_waitcnt vmcnt(14)
    v_cmp_ne_u32 vcc, s43, v236
    s_cbranch_vccnz PO4_SLOW
PO4_OK:
    s_barrier
    ds_read_b128 v[16:19], v244 offset:24576
    v_mfma_i32_16x16x64_i8 v[136:139], a[44:47], v[40:43], v[136:139]
    s_add_u32 s44, s61, 131072
    s_add_u32 m0, s61, 0
    v_mfma_i32_16x16x64_i8 v[144:147], a[108:111], v[40:43], v[144:147]
    ds_read_b128 v[20:23], v244 offset:24832
    v_permlane32_swap_b32 v94, v95
    v_mfma_i32_16x16x64_i8 v[140:143], a[44:47], v[44:47], v[140:143]
    buffer_load_dwordx4 v3, s[36:39], s44 offen offset:0 sc1 lds
    v_mfma_i32_16x16x64_i8 v[148:151], a[108:111], v[44:47], v[148:151]
    ds_read_b128 v[24:27], v244 offset:57344
    s_waitcnt lgkmcnt(3)
    v_mfma_i32_16x16x64_i8 v[152:155], a[44:47], v[48:51], v[152:155]
    v_add_u32 v92, v92, v93
    v_add_u32 v94, v94, v95
    v_mfma_i32_16x16x64_i8 v[160:163], a[108:111], v[48:51], v[160:163]
    ds_read_b128 v[28:31], v244 offset:57600
    s_nop 1
    v_mfma_i32_16x16x64_i8 v[156:159], a[44:47], v[52:55], v[156:159]
    buffer_load_dwordx4 v3, s[36:39], s44 offen offset:1024 sc1 lds
    v_mfma_i32_16x16x64_i8 v[164:167], a[108:111], v[52:55], v[164:167]
    ds_read_b128 v[32:35], v244 offset:26624
    v_permlane16_swap_b32 v92, v94
    v_mfma_i32_16x16x64_i8 v[168:171], a[44:47], v[56:59], v[168:171]
    v_add_u32 v92, v92, v94
    v_cvt_f32_i32 v92, v92
    v_mfma_i32_16x16x64_i8 v[176:179], a[108:111], v[56:59], v[176:179]
    ds_read_b128 v[36:39], v244 offset:26880
    v_cvt_pk_bf16_f32 v92, v92, v92
    v_mfma_i32_16x16x64_i8 v[172:175], a[44:47], v[60:63], v[172:175]
    buffer_load_dwordx4 v3, s[36:39], s44 offen offset:2048 sc1 lds
    v_mfma_i32_16x16x64_i8 v[180:183], a[108:111], v[60:63], v[180:183]
    ds_read_b128 v[40:43], v244 offset:59392
    s_waitcnt vmcnt(15) lgkmcnt(3)
    v_mfma_i32_16x16x64_i8 v[120:123], a[48:51], v[16:19], v[120:123]
    v_lshlrev_b32 v92, 16, v92
    v_mul_f32 v92, v92, v252
    v_mfma_i32_16x16x64_i8 v[128:131], a[112:115], v[16:19], v[128:131]
    ds_read_b128 v[44:47], v244 offset:59648
    v_cvt_pk_bf16_f32 v92, v92, v92
    v_mfma_i32_16x16x64_i8 v[124:127], a[48:51], v[20:23], v[124:127]
    buffer_load_dwordx4 v3, s[36:39], s44 offen offset:3072 sc1 lds
    v_mfma_i32_16x16x64_i8 v[132:135], a[112:115], v[20:23], v[132:135]
    s_waitcnt vmcnt(10)
    s_barrier
    ds_read_b128 v[48:51], v244 offset:28672
    v_mfma_i32_16x16x64_i8 v[136:139], a[48:51], v[24:27], v[136:139]
    buffer_load_dwordx2 v[8:9], v251, s[16:19], s35 offen offset:0 sc1
    v_mfma_i32_16x16x64_i8 v[144:147], a[112:115], v[24:27], v[144:147]
    ds_read_b128 v[52:55], v244 offset:28928
    v_lshlrev_b32 v92, 16, v92
    v_mfma_i32_16x16x64_i8 v[140:143], a[48:51], v[28:31], v[140:143]
    buffer_load_dwordx2 v[10:11], v251, s[16:19], s35 offen offset:512 sc1
    v_mfma_i32_16x16x64_i8 v[148:151], a[112:115], v[28:31], v[148:151]
    ds_read_b128 v[56:59], v244 offset:61440
    s_waitcnt lgkmcnt(3)
    v_mfma_i32_16x16x64_i8 v[120:123], a[52:55], v[32:35], v[120:123]
    buffer_load_dwordx2 v[12:13], v251, s[16:19], s35 offen offset:1024 sc1
    v_mfma_i32_16x16x64_i8 v[128:131], a[116:119], v[32:35], v[128:131]
    ds_read_b128 v[60:63], v244 offset:61696
    v_fma_f32 v239, -v92, v238, v239
    v_mfma_i32_16x16x64_i8 v[124:127], a[52:55], v[36:39], v[124:127]
    buffer_load_dwordx2 v[14:15], v251, s[16:19], s35 offen offset:1536 sc1
    v_mfma_i32_16x16x64_i8 v[132:135], a[116:119], v[36:39], v[132:135]
    ds_read_b128 v[16:19], v245 offset:24576
    s_add_u32 s44, s61, 147456
    v_mfma_i32_16x16x64_i8 v[136:139], a[52:55], v[40:43], v[136:139]
    s_add_u32 m0, s61, 32768
    v_fma_f32 v239, v238, s34, v239
    v_mfma_i32_16x16x64_i8 v[144:147], a[116:119], v[40:43], v[144:147]
    ds_read_b128 v[20:23], v245 offset:24832
    ds_write_b32 v250, v239 offset:1024
    v_mfma_i32_16x16x64_i8 v[140:143], a[52:55], v[44:47], v[140:143]
    buffer_load_dwordx4 v3, s[36:39], s44 offen offset:0 sc1 lds
    v_mfma_i32_16x16x64_i8 v[148:151], a[116:119], v[44:47], v[148:151]
    ds_read_b128 v[24:27], v245 offset:57344
    s_waitcnt vmcnt(13) lgkmcnt(4)
    v_mfma_i32_16x16x64_i8 v[120:123], a[56:59], v[48:51], v[120:123]
    buffer_load_dwordx4 v3, s[36:39], s44 offen offset:1024 sc1 lds
    v_mfma_i32_16x16x64_i8 v[128:131], a[120:123], v[48:51], v[128:131]
    ds_read_b128 v[28:31], v245 offset:57600
    v_mfma_i32_16x16x64_i8 v[124:127], a[56:59], v[52:55], v[124:127]
    buffer_load_dwordx4 v3, s[36:39], s44 offen offset:2048 sc1 lds
    v_mfma_i32_16x16x64_i8 v[132:135], a[120:123], v[52:55], v[132:135]
    ds_read_b128 v[32:35], v244 offset:30720
    v_mfma_i32_16x16x64_i8 v[136:139], a[56:59], v[56:59], v[136:139]
    buffer_load_dwordx4 v3, s[36:39], s44 offen offset:3072 sc1 lds
    v_mfma_i32_16x16x64_i8 v[144:147], a[120:123], v[56:59], v[144:147]
    ds_read_b128 v[36:39], v244 offset:30976
    s_add_u32 s44, s61, 163840
    v_mfma_i32_16x16x64_i8 v[140:143], a[56:59], v[60:63], v[140:143]
    s_add_u32 m0, s61, 65536
    v_mfma_i32_16x16x64_i8 v[148:151], a[120:123], v[60:63], v[148:151]
    ds_read_b128 v[40:43], v244 offset:63488
    s_waitcnt lgkmcnt(3)
    v_mfma_i32_16x16x64_i8 v[152:155], a[48:51], v[16:19], v[152:155]
    buffer_load_dwordx4 v3, s[36:39], s44 offen offset:0 sc1 lds
    v_mfma_i32_16x16x64_i8 v[160:163], a[112:115], v[16:19], v[160:163]
    ds_read_b128 v[44:47], v244 offset:63744
    v_mfma_i32_16x16x64_i8 v[156:159], a[48:51], v[20:23], v[156:159]
    v_mfma_i32_16x16x64_i8 v[164:167], a[112:115], v[20:23], v[164:167]
    ds_read_b128 v[48:51], v245 offset:26624
    v_mfma_i32_16x16x64_i8 v[168:171], a[48:51], v[24:27], v[168:171]
    buffer_load_dwordx4 v3, s[36:39], s44 offen offset:1024 sc1 lds
    v_mfma_i32_16x16x64_i8 v[176:179], a[112:115], v[24:27], v[176:179]
    ds_read_b128 v[52:55], v245 offset:26880
    v_mfma_i32_16x16x64_i8 v[172:175], a[48:51], v[28:31], v[172:175]
    v_mfma_i32_16x16x64_i8 v[180:183], a[112:115], v[28:31], v[180:183]
    ds_read_b128 v[56:59], v245 offset:59392
    s_waitcnt vmcnt(16) lgkmcnt(3)
    v_mfma_i32_16x16x64_i8 v[120:123], a[60:63], v[32:35], v[120:123]
    buffer_load_dwordx4 v3, s[36:39], s44 offen offset:2048 sc1 lds
    v_mfma_i32_16x16x64_i8 v[128:131], a[124:127], v[32:35], v[128:131]
    ds_read_b128 v[60:63], v245 offset:59648
    v_mfma_i32_16x16x64_i8 v[124:127], a[60:63], v[36:39], v[124:127]
    v_mfma_i32_16x16x64_i8 v[132:135], a[124:127], v[36:39], v[132:135]
    s_waitcnt vmcnt(15)
    s_barrier
    ds_read_b128 v[16:19], v245 offset:28672
    v_mfma_i32_16x16x64_i8 v[136:139], a[60:63], v[40:43], v[136:139]
    buffer_load_dwordx4 v3, s[36:39], s44 offen offset:3072 sc1 lds
    v_mfma_i32_16x16x64_i8 v[144:147], a[124:127], v[40:43], v[144:147]
    ds_read_b128 v[20:23], v245 offset:28928
    s_add_u32 s44, s61, 180224
    v_mfma_i32_16x16x64_i8 v[140:143], a[60:63], v[44:47], v[140:143]
    s_add_u32 m0, s61, 98304
    ds_read2_b32 v[66:67], v248 offset0:0 offset1:32
    v_mfma_i32_16x16x64_i8 v[148:151], a[124:127], v[44:47], v[148:151]
    ds_read_b128 v[24:27], v245 offset:30720
    s_waitcnt lgkmcnt(4)
    v_mfma_i32_16x16x64_i8 v[152:155], a[52:55], v[48:51], v[152:155]
    buffer_load_dwordx4 v3, s[36:39], s44 offen offset:0 sc1 lds
    v_mfma_i32_16x16x64_i8 v[160:163], a[116:119], v[48:51], v[160:163]
    ds_read_b128 v[28:31], v245 offset:30976
    ds_read2_b32 v[70:71], v248 offset0:16 offset1:48
    v_mfma_i32_16x16x64_i8 v[156:159], a[52:55], v[52:55], v[156:159]
    s_waitcnt lgkmcnt(3)
    v_fma_f32 v110, v120, v64, v66
    v_fma_f32 v111, v124, v65, v67
    v_mfma_i32_16x16x64_i8 v[164:167], a[116:119], v[52:55], v[164:167]
    ds_read_b128 v[32:35], v245 offset:61440
    v_cvt_pk_bf16_f32 v92, v110, v111
    v_mfma_i32_16x16x64_i8 v[168:171], a[52:55], v[56:59], v[168:171]
    buffer_load_dwordx4 v3, s[36:39], s44 offen offset:1024 sc1 lds
    v_mfma_i32_16x16x64_i8 v[176:179], a[116:119], v[56:59], v[176:179]
    ds_read_b128 v[36:39], v245 offset:61696
    s_waitcnt lgkmcnt(2)
    v_fma_f32 v110, v136, v68, v70
    v_mfma_i32_16x16x64_i8 v[172:175], a[52:55], v[60:63], v[172:175]
    v_fma_f32 v111, v140, v69, v71
    v_cvt_pk_bf16_f32 v93, v110, v111
    v_mfma_i32_16x16x64_i8 v[180:183], a[116:119], v[60:63], v[180:183]
    ds_read_b128 v[40:43], v245 offset:63488
    v_fma_f32 v110, v121, v64, v66
    v_mfma_i32_16x16x64_i8 v[152:155], a[56:59], v[16:19], v[152:155]
    buffer_store_dwordx2 v[92:93], v246, s[28:31], s68 offen offset:0 sc1 nt
    v_fma_f32 v111, v125, v65, v67
    v_mfma_i32_16x16x64_i8 v[160:163], a[120:123], v[16:19], v[160:163]
    ds_read_b128 v[44:47], v245 offset:63744
    v_cvt_pk_bf16_f32 v94, v110, v111
    v_mfma_i32_16x16x64_i8 v[156:159], a[56:59], v[20:23], v[156:159]
    buffer_load_dwordx4 v3, s[36:39], s44 offen offset:2048 sc1 lds
    v_mfma_i32_16x16x64_i8 v[164:167], a[120:123], v[20:23], v[164:167]
    s_waitcnt vmcnt(16)
    s_barrier
    ds_read_b128 v[48:51], v244 offset:0
    v_mfma_i32_16x16x64_i8 v[152:155], a[60:63], v[24:27], v[152:155]
    buffer_load_dwordx4 v3, s[36:39], s44 offen offset:3072 sc1 lds
    v_mfma_i32_16x16x64_i8 v[160:163], a[124:127], v[24:27], v[160:163]
    ds_read_b128 v[52:55], v244 offset:256
    s_add_u32 s44, s61, 196608
    v_mfma_i32_16x16x64_i8 v[156:159], a[60:63], v[28:31], v[156:159]
    s_add_u32 m0, s61, 16384
    v_fma_f32 v110, v137, v68, v70
    v_mfma_i32_16x16x64_i8 v[164:167], a[124:127], v[28:31], v[164:167]
    ds_read_b128 v[56:59], v244 offset:2048
    s_waitcnt lgkmcnt(3)
    v_mfma_i32_16x16x64_i8 v[168:171], a[56:59], v[32:35], v[168:171]
    v_fma_f32 v111, v141, v69, v71
    v_cvt_pk_bf16_f32 v95, v110, v111
    v_mfma_i32_16x16x64_i8 v[176:179], a[120:123], v[32:35], v[176:179]
    ds_read_b128 v[60:63], v244 offset:2304
    v_fma_f32 v110, v122, v64, v66
    v_mfma_i32_16x16x64_i8 v[172:175], a[56:59], v[36:39], v[172:175]
    buffer_store_dwordx2 v[94:95], v246, s[28:31], s69 offen offset:0 sc1 nt
    v_fma_f32 v111, v126, v65, v67
    v_mfma_i32_16x16x64_i8 v[180:183], a[120:123], v[36:39], v[180:183]
    ds_read_b128 v[16:19], v244 offset:4096
    v_cvt_pk_bf16_f32 v96, v110, v111
    v_mfma_i32_16x16x64_i8 v[168:171], a[60:63], v[40:43], v[168:171]
    buffer_load_dwordx4 v3, s[36:39], s44 offen offset:0 sc1 lds
    v_mfma_i32_16x16x64_i8 v[176:179], a[124:127], v[40:43], v[176:179]
    ds_read_b128 v[20:23], v244 offset:4352
    v_fma_f32 v110, v138, v68, v70
    v_mfma_i32_16x16x64_i8 v[172:175], a[60:63], v[44:47], v[172:175]
    v_fma_f32 v111, v142, v69, v71
    v_cvt_pk_bf16_f32 v97, v110, v111
    v_mfma_i32_16x16x64_i8 v[180:183], a[124:127], v[44:47], v[180:183]
    ds_read_b128 v[24:27], v244 offset:6144
    s_waitcnt lgkmcnt(3)
    v_mfma_i32_16x16x64_i8 v[184:187], a[0:3], v[48:51], v[112:115]
    v_fma_f32 v110, v123, v64, v66
    v_fma_f32 v111, v127, v65, v67
    v_mfma_i32_16x16x64_i8 v[192:195], a[64:67], v[48:51], v[112:115]
    ds_read_b128 v[28:31], v244 offset:6400
    v_cvt_pk_bf16_f32 v98, v110, v111
    v_mfma_i32_16x16x64_i8 v[188:191], a[0:3], v[52:55], v[112:115]
    buffer_load_dwordx4 v3, s[36:39], s44 offen offset:1024 sc1 lds
    v_mfma_i32_16x16x64_i8 v[196:199], a[64:67], v[52:55], v[112:115]
    ds_read_b128 v[32:35], v244 offset:8192
    v_fma_f32 v110, v139, v68, v70
    v_mfma_i32_16x16x64_i8 v[184:187], a[4:7], v[56:59], v[184:187]
    buffer_store_dwordx2 v[96:97], v246, s[28:31], s70 offen offset:0 sc1 nt
    v_fma_f32 v111, v143, v69, v71
    v_mfma_i32_16x16x64_i8 v[192:195], a[68:71], v[56:59], v[192:195]
    ds_read_b128 v[36:39], v244 offset:8448
    v_cvt_pk_bf16_f32 v99, v110, v111
    v_mfma_i32_16x16x64_i8 v[188:191], a[4:7], v[60:63], v[188:191]
    v_fma_f32 v110, v128, v64, v66
    v_fma_f32 v111, v132, v65, v67
    v_mfma_i32_16x16x64_i8 v[196:199], a[68:71], v[60:63], v[196:199]
    ds_read_b128 v[40:43], v244 offset:10240
    s_waitcnt lgkmcnt(3)
    v_mfma_i32_16x16x64_i8 v[184:187], a[8:11], v[16:19], v[184:187]
    buffer_load_dwordx4 v3, s[36:39], s44 offen offset:2048 sc1 lds
    v_mfma_i32_16x16x64_i8 v[192:195], a[72:75], v[16:19], v[192:195]
    ds_read_b128 v[44:47], v244 offset:10496
    v_cvt_pk_bf16_f32 v100, v110, v111
    v_mfma_i32_16x16x64_i8 v[188:191], a[8:11], v[20:23], v[188:191]
    v_fma_f32 v110, v144, v68, v70
    v_fma_f32 v111, v148, v69, v71
    v_mfma_i32_16x16x64_i8 v[196:199], a[72:75], v[20:23], v[196:199]
    ds_read_b128 v[48:51], v244 offset:12288
    v_cvt_pk_bf16_f32 v101, v110, v111
    v_mfma_i32_16x16x64_i8 v[184:187], a[12:15], v[24:27], v[184:187]
    v_mfma_i32_16x16x64_i8 v[192:195], a[76:79], v[24:27], v[192:195]
    ds_read_b128 v[52:55], v244 offset:12544
    v_mfma_i32_16x16x64_i8 v[188:191], a[12:15], v[28:31], v[188:191]
    buffer_store_dwordx2 v[98:99], v246, s[28:31], s71 offen offset:0 sc1 nt
    v_fma_f32 v110, v129, v64, v66
    v_mfma_i32_16x16x64_i8 v[196:199], a[76:79], v[28:31], v[196:199]
    ds_read_b128 v[56:59], v244 offset:14336
    s_waitcnt lgkmcnt(3)
    v_mfma_i32_16x16x64_i8 v[184:187], a[16:19], v[32:35], v[184:187]
    buffer_load_dwordx4 v3, s[36:39], s44 offen offset:3072 sc1 lds
    v_mfma_i32_16x16x64_i8 v[192:195], a[80:83], v[32:35], v[192:195]
    ds_read_b128 v[60:63], v244 offset:14592
    s_add_u32 s44, s61, 212992
    v_mfma_i32_16x16x64_i8 v[188:191], a[16:19], v[36:39], v[188:191]
    s_add_u32 m0, s61, 49152
    v_fma_f32 v111, v133, v65, v67
    v_mfma_i32_16x16x64_i8 v[196:199], a[80:83], v[36:39], v[196:199]
    s_waitcnt vmcnt(16)
    s_barrier
    ds_read_b128 v[16:19], v244 offset:32768
    v_mfma_i32_16x16x64_i8 v[184:187], a[20:23], v[40:43], v[184:187]
    v_cvt_pk_bf16_f32 v102, v110, v111
    v_fma_f32 v110, v145, v68, v70
    v_mfma_i32_16x16x64_i8 v[192:195], a[84:87], v[40:43], v[192:195]
    ds_read_b128 v[20:23], v244 offset:33024
    v_fma_f32 v111, v149, v69, v71
    v_mfma_i32_16x16x64_i8 v[188:191], a[20:23], v[44:47], v[188:191]
    buffer_load_dwordx4 v3, s[36:39], s44 offen offset:0 sc1 lds
    v_mfma_i32_16x16x64_i8 v[196:199], a[84:87], v[44:47], v[196:199]
    ds_read_b128 v[24:27], v244 offset:34816
    s_waitcnt lgkmcnt(3)
    v_mfma_i32_16x16x64_i8 v[184:187], a[24:27], v[48:51], v[184:187]
    v_cvt_pk_bf16_f32 v103, v110, v111
    v_mfma_i32_16x16x64_i8 v[192:195], a[88:91], v[48:51], v[192:195]
    ds_read_b128 v[28:31], v244 offset:35072
    v_mfma_i32_16x16x64_i8 v[188:191], a[24:27], v[52:55], v[188:191]
    buffer_store_dwordx2 v[100:101], v246, s[28:31], s72 offen offset:0 sc1 nt
    v_fma_f32 v110, v130, v64, v66
    v_mfma_i32_16x16x64_i8 v[196:199], a[88:91], v[52:55], v[196:199]
    ds_read_b128 v[32:35], v244 offset:36864
    v_fma_f32 v111, v134, v65, v67
    v_mfma_i32_16x16x64_i8 v[184:187], a[28:31], v[56:59], v[184:187]
    buffer_load_dwordx4 v3, s[36:39], s44 offen offset:1024 sc1 lds
    v_mfma_i32_16x16x64_i8 v[192:195], a[92:95], v[56:59], v[192:195]
    ds_read_b128 v[36:39], v244 offset:37120
    v_cvt_pk_bf16_f32 v104, v110, v111
    v_mfma_i32_16x16x64_i8 v[188:191], a[28:31], v[60:63], v[188:191]
    v_fma_f32 v110, v146, v68, v70
    v_fma_f32 v111, v150, v69, v71
    v_mfma_i32_16x16x64_i8 v[196:199], a[92:95], v[60:63], v[196:199]
    ds_read_b128 v[40:43], v244 offset:38912
    s_waitcnt lgkmcnt(3)
    v_mfma_i32_16x16x64_i8 v[184:187], a[32:35], v[16:19], v[184:187]
    v_cvt_pk_bf16_f32 v105, v110, v111
    v_mfma_i32_16x16x64_i8 v[192:195], a[96:99], v[16:19], v[192:195]
    ds_read_b128 v[44:47], v244 offset:39168
    v_mfma_i32_16x16x64_i8 v[188:191], a[32:35], v[20:23], v[188:191]
    buffer_load_dwordx4 v3, s[36:39], s44 offen offset:2048 sc1 lds
    v_mfma_i32_16x16x64_i8 v[196:199], a[96:99], v[20:23], v[196:199]
    ds_read_b128 v[48:51], v244 offset:40960
    v_mfma_i32_16x16x64_i8 v[184:187], a[36:39], v[24:27], v[184:187]
    buffer_store_dwordx2 v[102:103], v246, s[28:31], s73 offen offset:0 sc1 nt
    v_fma_f32 v110, v131, v64, v66
    v_mfma_i32_16x16x64_i8 v[192:195], a[100:103], v[24:27], v[192:195]
    ds_read_b128 v[52:55], v244 offset:41216
    v_fma_f32 v111, v135, v65, v67
    v_mfma_i32_16x16x64_i8 v[188:191], a[36:39], v[28:31], v[188:191]
    v_cvt_pk_bf16_f32 v106, v110, v111
    v_fma_f32 v110, v147, v68, v70
    v_mfma_i32_16x16x64_i8 v[196:199], a[100:103], v[28:31], v[196:199]
    ds_read_b128 v[56:59], v244 offset:43008
    s_waitcnt lgkmcnt(3)
    v_mfma_i32_16x16x64_i8 v[184:187], a[40:43], v[32:35], v[184:187]
    buffer_load_dwordx4 v3, s[36:39], s44 offen offset:3072 sc1 lds
    v_mfma_i32_16x16x64_i8 v[192:195], a[104:107], v[32:35], v[192:195]
    ds_read_b128 v[60:63], v244 offset:43264
    v_fma_f32 v111, v151, v69, v71
    v_mfma_i32_16x16x64_i8 v[188:191], a[40:43], v[36:39], v[188:191]
    v_cvt_pk_bf16_f32 v107, v110, v111
    v_mfma_i32_16x16x64_i8 v[196:199], a[104:107], v[36:39], v[196:199]
    ds_read_b128 v[16:19], v244 offset:45056
    v_mfma_i32_16x16x64_i8 v[184:187], a[44:47], v[40:43], v[184:187]
    v_mfma_i32_16x16x64_i8 v[192:195], a[108:111], v[40:43], v[192:195]
    ds_read_b128 v[20:23], v244 offset:45312
    v_mfma_i32_16x16x64_i8 v[188:191], a[44:47], v[44:47], v[188:191]
    v_mfma_i32_16x16x64_i8 v[196:199], a[108:111], v[44:47], v[196:199]
    ds_read_b128 v[24:27], v244 offset:47104
    s_waitcnt lgkmcnt(3)
    v_mfma_i32_16x16x64_i8 v[184:187], a[48:51], v[48:51], v[184:187]
    buffer_store_dwordx2 v[104:105], v246, s[28:31], s74 offen offset:0 sc1 nt
    ds_read2_b32 v[74:75], v248 offset0:64 offset1:96
    v_mfma_i32_16x16x64_i8 v[192:195], a[112:115], v[48:51], v[192:195]
    ds_read_b128 v[28:31], v244 offset:47360
    ds_read2_b32 v[78:79], v248 offset0:80 offset1:112
    v_mfma_i32_16x16x64_i8 v[188:191], a[48:51], v[52:55], v[188:191]
    s_waitcnt lgkmcnt(2)
    v_fma_f32 v110, v152, v72, v74
    v_fma_f32 v111, v156, v73, v75
    v_mfma_i32_16x16x64_i8 v[196:199], a[112:115], v[52:55], v[196:199]
    s_waitcnt vmcnt(19)
    s_barrier
    ds_read_b128 v[32:35], v245 offset:0
    v_mfma_i32_16x16x64_i8 v[184:187], a[52:55], v[56:59], v[184:187]
    v_cvt_pk_bf16_f32 v92, v110, v111
    s_waitcnt lgkmcnt(1)
    v_fma_f32 v110, v168, v76, v78
    v_mfma_i32_16x16x64_i8 v[192:195], a[116:119], v[56:59], v[192:195]
    ds_read_b128 v[36:39], v245 offset:256
    v_fma_f32 v111, v172, v77, v79
    v_mfma_i32_16x16x64_i8 v[188:191], a[52:55], v[60:63], v[188:191]
    v_cvt_pk_bf16_f32 v93, v110, v111
    v_mfma_i32_16x16x64_i8 v[196:199], a[116:119], v[60:63], v[196:199]
    ds_read_b128 v[40:43], v245 offset:2048
    v_mfma_i32_16x16x64_i8 v[184:187], a[56:59], v[16:19], v[184:187]
    buffer_store_dwordx2 v[106:107], v246, s[28:31], s75 offen offset:0 sc1 nt
    v_fma_f32 v110, v153, v72, v74
    v_mfma_i32_16x16x64_i8 v[192:195], a[120:123], v[16:19], v[192:195]
    ds_read_b128 v[44:47], v245 offset:2304
    v_fma_f32 v111, v157, v73, v75
    v_mfma_i32_16x16x64_i8 v[188:191], a[56:59], v[20:23], v[188:191]
    v_cvt_pk_bf16_f32 v94, v110, v111
    v_fma_f32 v110, v169, v76, v78
    v_mfma_i32_16x16x64_i8 v[196:199], a[120:123], v[20:23], v[196:199]
    ds_read_b128 v[48:51], v245 offset:4096
    v_fma_f32 v111, v173, v77, v79
    v_mfma_i32_16x16x64_i8 v[184:187], a[60:63], v[24:27], v[184:187]
    v_cvt_pk_bf16_f32 v95, v110, v111
    v_pk_add_i16 v8, v8, v12
    v_mfma_i32_16x16x64_i8 v[192:195], a[124:127], v[24:27], v[192:195]
    ds_read_b128 v[52:55], v245 offset:4352
    v_pk_add_i16 v9, v9, v13
    v_mfma_i32_16x16x64_i8 v[188:191], a[60:63], v[28:31], v[188:191]
    v_pk_add_i16 v10, v10, v14
    v_pk_add_i16 v11, v11, v15
    v_mfma_i32_16x16x64_i8 v[196:199], a[124:127], v[28:31], v[196:199]
    ds_read_b128 v[56:59], v245 offset:6144
    s_waitcnt lgkmcnt(3)
    v_mfma_i32_16x16x64_i8 v[200:203], a[0:3], v[32:35], v[112:115]
    v_pk_add_i16 v8, v8, v10
    v_pk_add_i16 v9, v9, v11
    v_mfma_i32_16x16x64_i8 v[208:211], a[64:67], v[32:35], v[112:115]
    ds_read_b128 v[60:63], v245 offset:6400
    v_bfe_i32 v4, v8, 0, 16
    v_mfma_i32_16x16x64_i8 v[204:207], a[0:3], v[36:39], v[112:115]
    buffer_store_dwordx2 v[92:93], v246, s[28:31], s68 offen offset:128 sc1 nt
    v_fma_f32 v110, v154, v72, v74
    v_mfma_i32_16x16x64_i8 v[212:215], a[64:67], v[36:39], v[112:115]
    ds_read_b128 v[16:19], v245 offset:8192
    v_fma_f32 v111, v158, v73, v75
    v_mfma_i32_16x16x64_i8 v[200:203], a[4:7], v[40:43], v[200:203]
    v_cvt_pk_bf16_f32 v96, v110, v111
    v_fma_f32 v110, v170, v76, v78
    v_mfma_i32_16x16x64_i8 v[208:211], a[68:71], v[40:43], v[208:211]
    ds_read_b128 v[20:23], v245 offset:8448
    v_fma_f32 v111, v174, v77, v79
    v_mfma_i32_16x16x64_i8 v[204:207], a[4:7], v[44:47], v[204:207]
    v_cvt_pk_bf16_f32 v97, v110, v111
    v_ashrrev_i32 v5, 16, v8
    v_mfma_i32_16x16x64_i8 v[212:215], a[68:71], v[44:47], v[212:215]
    ds_read_b128 v[24:27], v245 offset:10240
    s_waitcnt lgkmcnt(3)
    v_mfma_i32_16x16x64_i8 v[200:203], a[8:11], v[48:51], v[200:203]
    v_bfe_i32 v6, v9, 0, 16
    v_ashrrev_i32 v7, 16, v9
    v_mfma_i32_16x16x64_i8 v[208:211], a[72:75], v[48:51], v[208:211]
    ds_read_b128 v[28:31], v245 offset:10496
    v_permlane32_swap_b32 v4, v5
    v_mfma_i32_16x16x64_i8 v[204:207], a[8:11], v[52:55], v[204:207]
    buffer_store_dwordx2 v[94:95], v246, s[28:31], s69 offen offset:128 sc1 nt
    v_fma_f32 v110, v155, v72, v74
    v_mfma_i32_16x16x64_i8 v[212:215], a[72:75], v[52:55], v[212:215]
    ds_read_b128 v[32:35], v245 offset:12288
    v_fma_f32 v111, v159, v73, v75
    v_mfma_i32_16x16x64_i8 v[200:203], a[12:15], v[56:59], v[200:203]
    v_cvt_pk_bf16_f32 v98, v110, v111
    v_fma_f32 v110, v171, v76, v78
    v_mfma_i32_16x16x64_i8 v[208:211], a[76:79], v[56:59], v[208:211]
    ds_read_b128 v[36:39], v245 offset:12544
    v_fma_f32 v111, v175, v77, v79
    v_mfma_i32_16x16x64_i8 v[204:207], a[12:15], v[60:63], v[204:207]
    v_cvt_pk_bf16_f32 v99, v110, v111
    s_nop 0
    v_mfma_i32_16x16x64_i8 v[212:215], a[76:79], v[60:63], v[212:215]
    ds_read_b128 v[40:43], v245 offset:14336
    s_waitcnt lgkmcnt(3)
    v_mfma_i32_16x16x64_i8 v[200:203], a[16:19], v[16:19], v[200:203]
    v_permlane32_swap_b32 v6, v7
    v_add_u32 v4, v4, v5
    v_mfma_i32_16x16x64_i8 v[208:211], a[80:83], v[16:19], v[208:211]
    ds_read_b128 v[44:47], v245 offset:14592
    v_add_u32 v6, v6, v7
    v_mfma_i32_16x16x64_i8 v[204:207], a[16:19], v[20:23], v[204:207]
    buffer_store_dwordx2 v[96:97], v246, s[28:31], s70 offen offset:128 sc1 nt
    v_fma_f32 v110, v160, v72, v74
    v_mfma_i32_16x16x64_i8 v[212:215], a[80:83], v[20:23], v[212:215]
    s_waitcnt vmcnt(18)
    s_barrier
    ds_read_b128 v[48:51], v245 offset:32768
    v_mfma_i32_16x16x64_i8 v[200:203], a[20:23], v[24:27], v[200:203]
    v_fma_f32 v111, v164, v73, v75
    v_cvt_pk_bf16_f32 v100, v110, v111
    v_mfma_i32_16x16x64_i8 v[208:211], a[84:87], v[24:27], v[208:211]
    ds_read_b128 v[52:55], v245 offset:33024
    v_fma_f32 v110, v176, v76, v78
    v_mfma_i32_16x16x64_i8 v[204:207], a[20:23], v[28:31], v[204:207]
    v_fma_f32 v111, v180, v77, v79
    v_cvt_pk_bf16_f32 v101, v110, v111
    v_mfma_i32_16x16x64_i8 v[212:215], a[84:87], v[28:31], v[212:215]
    ds_read_b128 v[56:59], v245 offset:34816
    s_waitcnt lgkmcnt(3)
    v_mfma_i32_16x16x64_i8 v[200:203], a[24:27], v[32:35], v[200:203]
    s_nop 1
    v_permlane16_swap_b32 v4, v6
    v_mfma_i32_16x16x64_i8 v[208:211], a[88:91], v[32:35], v[208:211]
    ds_read_b128 v[60:63], v245 offset:35072
    v_add_u32 v4, v4, v6
    v_mfma_i32_16x16x64_i8 v[204:207], a[24:27], v[36:39], v[204:207]
    v_cvt_f32_i32 v4, v4
    v_cvt_pk_bf16_f32 v4, v4, v4
    v_mfma_i32_16x16x64_i8 v[212:215], a[88:91], v[36:39], v[212:215]
    ds_read_b128 v[16:19], v245 offset:36864
    v_lshlrev_b32 v4, 16, v4
    v_mfma_i32_16x16x64_i8 v[200:203], a[28:31], v[40:43], v[200:203]
    buffer_store_dwordx2 v[98:99], v246, s[28:31], s71 offen offset:128 sc1 nt
ISL2:
    s_cbranch_vccnz WARMRET
    v_fma_f32 v110, v161, v72, v74
    v_mfma_i32_16x16x64_i8 v[208:211], a[92:95], v[40:43], v[208:211]
    ds_read_b128 v[20:23], v245 offset:37120
    v_fma_f32 v111, v165, v73, v75
    v_mfma_i32_16x16x64_i8 v[204:207], a[28:31], v[44:47], v[204:207]
    v_cvt_pk_bf16_f32 v102, v110, v111
    v_fma_f32 v110, v177, v76, v78
    v_mfma_i32_16x16x64_i8 v[212:215], a[92:95], v[44:47], v[212:215]
    ds_read_b128 v[24:27], v245 offset:38912
    s_waitcnt lgkmcnt(3)
    v_mfma_i32_16x16x64_i8 v[200:203], a[32:35], v[48:51], v[200:203]
    v_fma_f32 v111, v181, v77, v79
    v_cvt_pk_bf16_f32 v103, v110, v111
    v_mfma_i32_16x16x64_i8 v[208:211], a[96:99], v[48:51], v[208:211]
    ds_read_b128 v[28:31], v245 offset:39168
    v_mul_f32 v4, v4, v252
    v_mfma_i32_16x16x64_i8 v[204:207], a[32:35], v[52:55], v[204:207]
    v_cvt_pk_bf16_f32 v4, v4, v4
    v_lshlrev_b32 v4, 16, v4
    v_mfma_i32_16x16x64_i8 v[212:215], a[96:99], v[52:55], v[212:215]
    ds_read_b128 v[32:35], v245 offset:40960
    v_fma_f32 v239, -v4, v238, v239
    v_mfma_i32_16x16x64_i8 v[200:203], a[36:39], v[56:59], v[200:203]
    buffer_store_dwordx2 v[100:101], v246, s[28:31], s72 offen offset:128 sc1 nt
    v_fma_f32 v110, v162, v72, v74
    v_mfma_i32_16x16x64_i8 v[208:211], a[100:103], v[56:59], v[208:211]
    ds_read_b128 v[36:39], v245 offset:41216
    v_fma_f32 v111, v166, v73, v75
    v_mfma_i32_16x16x64_i8 v[204:207], a[36:39], v[60:63], v[204:207]
    v_cvt_pk_bf16_f32 v104, v110, v111
    v_fma_f32 v110, v178, v76, v78
    v_mfma_i32_16x16x64_i8 v[212:215], a[100:103], v[60:63], v[212:215]
    ds_read_b128 v[40:43], v245 offset:43008
    s_waitcnt lgkmcnt(3)
    v_mfma_i32_16x16x64_i8 v[200:203], a[40:43], v[16:19], v[200:203]
    v_fma_f32 v111, v182, v77, v79
    v_cvt_pk_bf16_f32 v105, v110, v111
    v_mfma_i32_16x16x64_i8 v[208:211], a[104:107], v[16:19], v[208:211]
    ds_read_b128 v[44:47], v245 offset:43264
    v_fma_f32 v239, v238, s64, v239
    v_mfma_i32_16x16x64_i8 v[204:207], a[40:43], v[20:23], v[204:207]
    ds_write_b32 v250, v239 offset:1024
    v_or_b32 v116, v120, v121
    v_mfma_i32_16x16x64_i8 v[212:215], a[104:107], v[20:23], v[212:215]
    ds_read_b128 v[48:51], v245 offset:45056
    v_or_b32 v117, v122, v123
    v_mfma_i32_16x16x64_i8 v[200:203], a[44:47], v[24:27], v[200:203]
    buffer_store_dwordx2 v[102:103], v246, s[28:31], s73 offen offset:128 sc1 nt
    v_fma_f32 v110, v163, v72, v74
    v_mfma_i32_16x16x64_i8 v[208:211], a[108:111], v[24:27], v[208:211]
    ds_read_b128 v[52:55], v245 offset:45312
    v_fma_f32 v111, v167, v73, v75
    v_mfma_i32_16x16x64_i8 v[204:207], a[44:47], v[28:31], v[204:207]
    v_cvt_pk_bf16_f32 v106, v110, v111
    v_fma_f32 v110, v179, v76, v78
    v_mfma_i32_16x16x64_i8 v[212:215], a[108:111], v[28:31], v[212:215]
    ds_read_b128 v[56:59], v245 offset:47104
    s_waitcnt lgkmcnt(4)
    v_mfma_i32_16x16x64_i8 v[200:203], a[48:51], v[32:35], v[200:203]
    v_fma_f32 v111, v183, v77, v79
    v_cvt_pk_bf16_f32 v107, v110, v111
    v_mfma_i32_16x16x64_i8 v[208:211], a[112:115], v[32:35], v[208:211]
    ds_read_b128 v[60:63], v245 offset:47360
    v_or3_b32 v116, v116, v124, v125
    v_mfma_i32_16x16x64_i8 v[204:207], a[48:51], v[36:39], v[204:207]
    v_or3_b32 v117, v117, v126, v127
    v_or3_b32 v116, v116, v128, v129
    v_mfma_i32_16x16x64_i8 v[212:215], a[112:115], v[36:39], v[212:215]
    s_waitcnt vmcnt(14) lgkmcnt(4)
    s_barrier
    ds_read_b128 v[16:19], v244 offset:16384
    v_mfma_i32_16x16x64_i8 v[200:203], a[52:55], v[40:43], v[200:203]
    buffer_store_dwordx2 v[104:105], v246, s[28:31], s74 offen offset:128 sc1 nt
    v_or3_b32 v117, v117, v130, v131
    v_mfma_i32_16x16x64_i8 v[208:211], a[116:119], v[40:43], v[208:211]
    ds_read_b128 v[20:23], v244 offset:16640
    ds_read2_b32 v[82:83], v248 offset0:128 offset1:160
    v_mfma_i32_16x16x64_i8 v[204:207], a[52:55], v[44:47], v[204:207]
    ds_read2_b32 v[86:87], v248 offset0:144 offset1:176
    ds_read2_b32 v[90:91], v249 offset0:192 offset1:224
    v_mfma_i32_16x16x64_i8 v[212:215], a[116:119], v[44:47], v[212:215]
    ds_read_b128 v[24:27], v244 offset:18432
    s_waitcnt lgkmcnt(6)
    v_mfma_i32_16x16x64_i8 v[200:203], a[56:59], v[48:51], v[200:203]
    s_waitcnt lgkmcnt(3)
    v_fma_f32 v110, v184, v80, v82
    v_fma_f32 v111, v188, v81, v83
    v_mfma_i32_16x16x64_i8 v[208:211], a[120:123], v[48:51], v[208:211]
    ds_read_b128 v[28:31], v244 offset:18688
    v_cvt_pk_bf16_f32 v92, v110, v111
    v_mfma_i32_16x16x64_i8 v[204:207], a[56:59], v[52:55], v[204:207]
    v_fma_f32 v110, v185, v80, v82
    v_fma_f32 v111, v189, v81, v83
    v_mfma_i32_16x16x64_i8 v[212:215], a[120:123], v[52:55], v[212:215]
    ds_read_b128 v[32:35], v244 offset:20480
    v_cvt_pk_bf16_f32 v94, v110, v111
    v_mfma_i32_16x16x64_i8 v[200:203], a[60:63], v[56:59], v[200:203]
    v_fma_f32 v110, v186, v80, v82
    v_fma_f32 v111, v190, v81, v83
    v_mfma_i32_16x16x64_i8 v[208:211], a[124:127], v[56:59], v[208:211]
    ds_read_b128 v[36:39], v244 offset:20736
    v_cvt_pk_bf16_f32 v96, v110, v111
    v_mfma_i32_16x16x64_i8 v[204:207], a[60:63], v[60:63], v[204:207]
    buffer_store_dwordx2 v[106:107], v246, s[28:31], s75 offen offset:128 sc1 nt
    v_fma_f32 v110, v187, v80, v82
    v_mfma_i32_16x16x64_i8 v[212:215], a[124:127], v[60:63], v[212:215]
    ds_read_b128 v[40:43], v244 offset:22528
    s_waitcnt lgkmcnt(3)
    v_mfma_i32_16x16x64_i8 v[216:219], a[0:3], v[16:19], v[112:115]
    v_fma_f32 v111, v191, v81, v83
    v_cvt_pk_bf16_f32 v98, v110, v111
    v_mfma_i32_16x16x64_i8 v[224:227], a[64:67], v[16:19], v[112:115]
    ds_read_b128 v[44:47], v244 offset:22784
    v_fma_f32 v110, v192, v80, v82
    v_mfma_i32_16x16x64_i8 v[220:223], a[0:3], v[20:23], v[112:115]
    v_fma_f32 v111, v196, v81, v83
    v_cvt_pk_bf16_f32 v100, v110, v111
    v_mfma_i32_16x16x64_i8 v[228:231], a[64:67], v[20:23], v[112:115]
    ds_read_b128 v[48:51], v244 offset:24576
    v_fma_f32 v110, v200, v84, v86
    v_mfma_i32_16x16x64_i8 v[216:219], a[4:7], v[24:27], v[216:219]
    v_fma_f32 v111, v204, v85, v87
    v_cvt_pk_bf16_f32 v93, v110, v111
    v_mfma_i32_16x16x64_i8 v[224:227], a[68:71], v[24:27], v[224:227]
    ds_read_b128 v[52:55], v244 offset:24832
    v_fma_f32 v110, v201, v84, v86
    v_mfma_i32_16x16x64_i8 v[220:223], a[4:7], v[28:31], v[220:223]
    buffer_store_dwordx2 v[92:93], v246, s[28:31], s68 offen offset:256 sc1 nt
    v_fma_f32 v111, v205, v85, v87
    v_mfma_i32_16x16x64_i8 v[228:231], a[68:71], v[28:31], v[228:231]
    ds_read_b128 v[56:59], v244 offset:26624
    s_waitcnt lgkmcnt(3)
    v_mfma_i32_16x16x64_i8 v[216:219], a[8:11], v[32:35], v[216:219]
    v_cvt_pk_bf16_f32 v95, v110, v111
    v_fma_f32 v110, v202, v84, v86
    v_mfma_i32_16x16x64_i8 v[224:227], a[72:75], v[32:35], v[224:227]
    ds_read_b128 v[60:63], v244 offset:26880
    v_fma_f32 v111, v206, v85, v87
    v_mfma_i32_16x16x64_i8 v[220:223], a[8:11], v[36:39], v[220:223]
    v_cvt_pk_bf16_f32 v97, v110, v111
    v_or3_b32 v116, v116, v132, v133
    v_mfma_i32_16x16x64_i8 v[228:231], a[72:75], v[36:39], v[228:231]
    ds_read_b128 v[16:19], v244 offset:28672
    v_or3_b32 v117, v117, v134, v135
    v_mfma_i32_16x16x64_i8 v[216:219], a[12:15], v[40:43], v[216:219]
    v_or3_b32 v116, v116, v136, v137
    v_or3_b32 v117, v117, v138, v139
    v_mfma_i32_16x16x64_i8 v[224:227], a[76:79], v[40:43], v[224:227]
    ds_read_b128 v[20:23], v244 offset:28928
    v_or3_b32 v116, v116, v140, v141
    v_mfma_i32_16x16x64_i8 v[220:223], a[12:15], v[44:47], v[220:223]
    buffer_store_dwordx2 v[94:95], v246, s[28:31], s69 offen offset:256 sc1 nt
    v_fma_f32 v110, v203, v84, v86
    v_mfma_i32_16x16x64_i8 v[228:231], a[76:79], v[44:47], v[228:231]
    ds_read_b128 v[24:27], v244 offset:30720
    s_waitcnt lgkmcnt(3)
    v_mfma_i32_16x16x64_i8 v[216:219], a[16:19], v[48:51], v[216:219]
    v_fma_f32 v111, v207, v85, v87
    v_cvt_pk_bf16_f32 v99, v110, v111
    v_mfma_i32_16x16x64_i8 v[224:227], a[80:83], v[48:51], v[224:227]
    ds_read_b128 v[28:31], v244 offset:30976
    s_waitcnt vmcnt(12)
    s_barrier
    ds_read_b128 a[128:131], v244 offset:49152
    v_mfma_i32_16x16x64_i8 v[220:223], a[16:19], v[52:55], v[220:223]
    v_or3_b32 v117, v117, v142, v143
    v_or3_b32 v116, v116, v144, v145
    v_mfma_i32_16x16x64_i8 v[228:231], a[80:83], v[52:55], v[228:231]
    ds_read_b128 a[132:135], v244 offset:49408
    ds_read_b128 a[136:139], v244 offset:51200
    v_mfma_i32_16x16x64_i8 v[216:219], a[20:23], v[56:59], v[216:219]
    v_or3_b32 v117, v117, v146, v147
    v_or3_b32 v116, v116, v148, v149
    v_mfma_i32_16x16x64_i8 v[224:227], a[84:87], v[56:59], v[224:227]
    ds_read_b128 a[140:143], v244 offset:51456
    ds_read_b128 a[144:147], v244 offset:53248
    v_mfma_i32_16x16x64_i8 v[220:223], a[20:23], v[60:63], v[220:223]
    v_or3_b32 v117, v117, v150, v151
    v_or3_b32 v116, v116, v152, v153
    v_mfma_i32_16x16x64_i8 v[228:231], a[84:87], v[60:63], v[228:231]
    ds_read_b128 a[148:151], v244 offset:53504
    ds_read_b128 a[152:155], v244 offset:55296
    s_waitcnt lgkmcnt(7)
    v_mfma_i32_16x16x64_i8 v[216:219], a[24:27], v[16:19], v[216:219]
    buffer_store_dwordx2 v[96:97], v246, s[28:31], s70 offen offset:256 sc1 nt
    v_fma_f32 v110, v208, v84, v86
    v_mfma_i32_16x16x64_i8 v[224:227], a[88:91], v[16:19], v[224:227]
    ds_read_b128 a[156:159], v244 offset:55552
    ds_read_b128 a[160:163], v244 offset:57344
    v_mfma_i32_16x16x64_i8 v[220:223], a[24:27], v[20:23], v[220:223]
    v_fma_f32 v111, v212, v85, v87
    v_cvt_pk_bf16_f32 v101, v110, v111
    v_mfma_i32_16x16x64_i8 v[228:231], a[88:91], v[20:23], v[228:231]
    ds_read_b128 a[164:167], v244 offset:57600
    ds_read_b128 a[168:171], v244 offset:59392
    v_mfma_i32_16x16x64_i8 v[216:219], a[28:31], v[24:27], v[216:219]
    v_or3_b32 v117, v117, v154, v155
    v_or3_b32 v116, v116, v156, v157
    v_mfma_i32_16x16x64_i8 v[224:227], a[92:95], v[24:27], v[224:227]
    ds_read_b128 a[172:175], v244 offset:59648
    ds_read_b128 a[176:179], v244 offset:61440
    v_mfma_i32_16x16x64_i8 v[220:223], a[28:31], v[28:31], v[220:223]
    v_or3_b32 v117, v117, v158, v159
    v_or3_b32 v116, v116, v160, v161
    v_mfma_i32_16x16x64_i8 v[228:231], a[92:95], v[28:31], v[228:231]
    ds_read_b128 a[180:183], v244 offset:61696
    ds_read_b128 a[184:187], v244 offset:63488
    s_waitcnt lgkmcnt(11)
    v_mfma_i32_16x16x64_i8 v[216:219], a[32:35], a[128:131], v[216:219]
    ds_read_b128 a[188:191], v244 offset:63744
    v_or3_b32 v117, v117, v162, v163
    v_mfma_i32_16x16x64_i8 v[220:223], a[32:35], a[132:135], v[220:223]
    buffer_store_dwordx2 v[98:99], v246, s[28:31], s71 offen offset:256 sc1 nt
    v_fma_f32 v110, v193, v80, v82
    v_mfma_i32_16x16x64_i8 v[216:219], a[36:39], a[136:139], v[216:219]
    v_fma_f32 v111, v197, v81, v83
    v_cvt_pk_bf16_f32 v102, v110, v111
    v_mfma_i32_16x16x64_i8 v[220:223], a[36:39], a[140:143], v[220:223]
    s_waitcnt lgkmcnt(8)
    v_fma_f32 v110, v209, v84, v86
    v_mfma_i32_16x16x64_i8 v[216:219], a[40:43], a[144:147], v[216:219]
    v_fma_f32 v111, v213, v85, v87
    v_cvt_pk_bf16_f32 v103, v110, v111
    v_mfma_i32_16x16x64_i8 v[220:223], a[40:43], a[148:151], v[220:223]
    v_or3_b32 v116, v116, v164, v165
    v_or3_b32 v117, v117, v166, v167
    v_mfma_i32_16x16x64_i8 v[216:219], a[44:47], a[152:155], v[216:219]
    v_or3_b32 v116, v116, v168, v169
    v_or3_b32 v117, v117, v170, v171
    v_mfma_i32_16x16x64_i8 v[220:223], a[44:47], a[156:159], v[220:223]
    s_waitcnt lgkmcnt(4)
    v_or3_b32 v116, v116, v172, v173
    v_mfma_i32_16x16x64_i8 v[216:219], a[48:51], a[160:163], v[216:219]
    buffer_store_dwordx2 v[100:101], v246, s[28:31], s72 offen offset:256 sc1 nt
    v_fma_f32 v110, v194, v80, v82
    v_mfma_i32_16x16x64_i8 v[220:223], a[48:51], a[164:167], v[220:223]
    v_fma_f32 v111, v198, v81, v83
    v_cvt_pk_bf16_f32 v104, v110, v111
    v_mfma_i32_16x16x64_i8 v[216:219], a[52:55], a[168:171], v[216:219]
    v_fma_f32 v110, v210, v84, v86
    v_fma_f32 v111, v214, v85, v87
    v_mfma_i32_16x16x64_i8 v[220:223], a[52:55], a[172:175], v[220:223]
    s_waitcnt lgkmcnt(0)
    v_cvt_pk_bf16_f32 v105, v110, v111
    v_mfma_i32_16x16x64_i8 v[216:219], a[56:59], a[176:179], v[216:219]
    v_or3_b32 v117, v117, v174, v175
    v_or3_b32 v116, v116, v176, v177
    v_mfma_i32_16x16x64_i8 v[220:223], a[56:59], a[180:183], v[220:223]
    v_or3_b32 v117, v117, v178, v179
    v_or3_b32 v116, v116, v180, v181
    v_mfma_i32_16x16x64_i8 v[216:219], a[60:63], a[184:187], v[216:219]
    v_or3_b32 v117, v117, v182, v183
    v_or3_b32 v116, v116, v184, v185
    v_mfma_i32_16x16x64_i8 v[220:223], a[60:63], a[188:191], v[220:223]
    v_mfma_i32_16x16x64_i8 v[224:227], a[96:99], a[128:131], v[224:227]
    v_or3_b32 v117, v117, v186, v187
    v_or3_b32 v116, v116, v188, v189
    v_mfma_i32_16x16x64_i8 v[228:231], a[96:99], a[132:135], v[228:231]
    buffer_store_dwordx2 v[102:103], v246, s[28:31], s73 offen offset:256 sc1 nt
    v_fma_f32 v110, v195, v80, v82
    v_mfma_i32_16x16x64_i8 v[224:227], a[100:103], a[136:139], v[224:227]
    v_fma_f32 v111, v199, v81, v83
    v_cvt_pk_bf16_f32 v106, v110, v111
    v_mfma_i32_16x16x64_i8 v[228:231], a[100:103], a[140:143], v[228:231]
    v_fma_f32 v110, v211, v84, v86
    v_fma_f32 v111, v215, v85, v87
    v_mfma_i32_16x16x64_i8 v[224:227], a[104:107], a[144:147], v[224:227]
    v_cvt_pk_bf16_f32 v107, v110, v111
    v_or3_b32 v117, v117, v190, v191
    v_mfma_i32_16x16x64_i8 v[228:231], a[104:107], a[148:151], v[228:231]
    v_or3_b32 v116, v116, v192, v193
    v_or3_b32 v117, v117, v194, v195
    v_mfma_i32_16x16x64_i8 v[224:227], a[108:111], a[152:155], v[224:227]
    v_or3_b32 v116, v116, v196, v197
    v_or3_b32 v117, v117, v198, v199
    v_mfma_i32_16x16x64_i8 v[228:231], a[108:111], a[156:159], v[228:231]
    v_or3_b32 v116, v116, v200, v201
    v_or3_b32 v117, v117, v202, v203
    v_mfma_i32_16x16x64_i8 v[224:227], a[112:115], a[160:163], v[224:227]
    v_or3_b32 v116, v116, v204, v205
    v_or3_b32 v117, v117, v206, v207
    v_mfma_i32_16x16x64_i8 v[228:231], a[112:115], a[164:167], v[228:231]
    buffer_store_dwordx2 v[104:105], v246, s[28:31], s74 offen offset:256 sc1 nt
    v_fma_f32 v110, v216, v88, v90
    v_mfma_i32_16x16x64_i8 v[224:227], a[116:119], a[168:171], v[224:227]
    v_fma_f32 v111, v220, v89, v91
    v_cvt_pk_bf16_f32 v92, v110, v111
    v_mfma_i32_16x16x64_i8 v[228:231], a[116:119], a[172:175], v[228:231]
    v_or3_b32 v116, v116, v208, v209
    v_or3_b32 v117, v117, v210, v211
    v_mfma_i32_16x16x64_i8 v[224:227], a[120:123], a[176:179], v[224:227]
    v_or3_b32 v116, v116, v212, v213
    v_or3_b32 v117, v117, v214, v215
    v_mfma_i32_16x16x64_i8 v[228:231], a[120:123], a[180:183], v[228:231]
    s_mov_b32 s34, 0x03800000
    v_or3_b32 v116, v116, v216, v217
    v_mfma_i32_16x16x64_i8 v[224:227], a[124:127], a[184:187], v[224:227]
    v_or3_b32 v117, v117, v218, v219
    v_or3_b32 v116, v116, v220, v221
    v_mfma_i32_16x16x64_i8 v[228:231], a[124:127], a[188:191], v[228:231]
    buffer_store_dwordx2 v[106:107], v246, s[28:31], s75 offen offset:256 sc1 nt
    buffer_store_dword v92, v247, s[28:31], s68 offen offset:0 sc1 nt
    v_fma_f32 v110, v217, v88, v90
    v_fma_f32 v111, v221, v89, v91
    v_cvt_pk_bf16_f32 v94, v110, v111
    buffer_store_dword v94, v247, s[28:31], s69 offen offset:0 sc1 nt
    v_fma_f32 v110, v218, v88, v90
    v_fma_f32 v111, v222, v89, v91
    v_cvt_pk_bf16_f32 v96, v110, v111
    buffer_store_dword v96, v247, s[28:31], s70 offen offset:0 sc1 nt
    v_fma_f32 v110, v219, v88, v90
    v_fma_f32 v111, v223, v89, v91
    v_cvt_pk_bf16_f32 v98, v110, v111
    buffer_store_dword v98, v247, s[28:31], s71 offen offset:0 sc1 nt
    v_fma_f32 v110, v224, v88, v90
    v_fma_f32 v111, v228, v89, v91
    v_cvt_pk_bf16_f32 v100, v110, v111
    buffer_store_dword v100, v247, s[28:31], s72 offen offset:0 sc1 nt
    v_fma_f32 v110, v225, v88, v90
    v_fma_f32 v111, v229, v89, v91
    v_cvt_pk_bf16_f32 v102, v110, v111
    buffer_store_dword v102, v247, s[28:31], s73 offen offset:0 sc1 nt
    v_fma_f32 v110, v226, v88, v90
    v_fma_f32 v111, v230, v89, v91
    v_cvt_pk_bf16_f32 v104, v110, v111
    buffer_store_dword v104, v247, s[28:31], s74 offen offset:0 sc1 nt
    v_fma_f32 v110, v227, v88, v90
    v_fma_f32 v111, v231, v89, v91
    v_cvt_pk_bf16_f32 v106, v110, v111
    buffer_store_dword v106, v247, s[28:31], s75 offen offset:0 sc1 nt
    v_or3_b32 v117, v117, v222, v223
    v_or_b32 v116, v116, v117
    v_or3_b32 v117, v224, v225, v226
    v_or3_b32 v116, v116, v227, v228
    v_or3_b32 v117, v117, v229, v230
    v_or3_b32 v116, v116, v117, v231
    v_and_b32 v116, s34, v116
    v_cmp_ne_u32 vcc, 0, v116
    s_cbranch_vccnz WIDE
K_END:
    s_endpgm
PO0_SLOW:
    s_mov_b32 s55, 200000
PO0_RETRY:
    s_sleep 1
    buffer_load_dword v236, v233, s[16:19], s53 offen sc1
    s_sub_u32 s55, s55, 1
    s_cmp_eq_u32 s55, 0
    s_cbranch_scc1 PO0_OUT
    s_waitcnt vmcnt(0)
    v_cmp_ne_u32 vcc, s43, v236
    s_nop 0
    s_cmp_lg_u64 vcc, 0
    s_cbranch_scc1 PO0_RETRY
PO0_OUT:
    s_mov_b64 vcc, 0
    s_branch PO0_OK
PO1_SLOW:
    s_mov_b32 s55, 200000
PO1_RETRY:
    s_sleep 1
    buffer_load_dword v236, v233, s[16:19], s53 offen sc1
    s_sub_u32 s55, s55, 1
    s_cmp_eq_u32 s55, 0
    s_cbranch_scc1 PO1_OUT
    s_waitcnt vmcnt(0)
    v_cmp_ne_u32 vcc, s43, v236
    s_nop 0
    s_cmp_lg_u64 vcc, 0
    s_cbranch_scc1 PO1_RETRY
PO1_OUT:
    s_mov_b64 vcc, 0
    s_branch PO1_OK
PO2_SLOW:
    s_mov_b32 s55, 200000
PO2_RETRY:
    s_sleep 1
    buffer_load_dword v236, v233, s[16:19], s53 offen sc1
    s_sub_u32 s55, s55, 1
    s_cmp_eq_u32 s55, 0
    s_cbranch_scc1 PO2_OUT
    s_waitcnt vmcnt(0)
    v_cmp_ne_u32 vcc, s43, v236
    s_nop 0
    s_cmp_lg_u64 vcc, 0
    s_cbranch_scc1 PO2_RETRY
PO2_OUT:
    s_mov_b64 vcc, 0
    s_branch PO2_OK
PO3_SLOW:
    s_mov_b32 s55, 200000
PO3_RETRY:
    s_sleep 1
    buffer_load_dword v236, v233, s[16:19], s53 offen sc1
    s_sub_u32 s55, s55, 1
    s_cmp_eq_u32 s55, 0
    s_cbranch_scc1 PO3_OUT
    s_waitcnt vmcnt(0)
    v_cmp_ne_u32 vcc, s43, v236
    s_nop 0
    s_cmp_lg_u64 vcc, 0
    s_cbranch_scc1 PO3_RETRY
PO3_OUT:
    s_mov_b64 vcc, 0
    s_branch PO3_OK
PO4_SLOW:
    s_mov_b32 s55, 200000
PO4_RETRY:
    s_sleep 1
    buffer_load_dword v236, v234, s[16:19], s53 offen sc1
    s_sub_u32 s55, s55, 1
    s_cmp_eq_u32 s55, 0
    s_cbranch_scc1 PO4_OUT
    s_waitcnt vmcnt(0)
    v_cmp_ne_u32 vcc, s43, v236
    s_nop 0
    s_cmp_lg_u64 vcc, 0
    s_cbranch_scc1 PO4_RETRY
PO4_OUT:
    s_mov_b64 vcc, 0
    s_branch PO4_OK
WIDE:
    s_waitcnt vmcnt(0)
    s_mov_b32 s34, 0x34800000
    v_sub_u32 v120, v120, v112
    v_cvt_f32_i32 v120, v120
    v_fma_f32 v120, v120, s34, v112
    v_sub_u32 v121, v121, v112
    v_cvt_f32_i32 v121, v121
    v_fma_f32 v121, v121, s34, v112
    v_sub_u32 v122, v122, v112
    v_cvt_f32_i32 v122, v122
    v_fma_f32 v122, v122, s34, v112
    v_sub_u32 v123, v123, v112
    v_cvt_f32_i32 v123, v123
    v_fma_f32 v123, v123, s34, v112
    v_sub_u32 v124, v124, v112
    v_cvt_f32_i32 v124, v124
    v_fma_f32 v124, v124, s34, v112
    v_sub_u32 v125, v125, v112
    v_cvt_f32_i32 v125, v125
    v_fma_f32 v125, v125, s34, v112
    v_sub_u32 v126, v126, v112
    v_cvt_f32_i32 v126, v126
    v_fma_f32 v126, v126, s34, v112
    v_sub_u32 v127, v127, v112
    v_cvt_f32_i32 v127, v127
    v_fma_f32 v127, v127, s34, v112
    v_sub_u32 v128, v128, v112
    v_cvt_f32_i32 v128, v128
    v_fma_f32 v128, v128, s34, v112
    v_sub_u32 v129, v129, v112
    v_cvt_f32_i32 v129, v129
    v_fma_f32 v129, v129, s34, v112
    v_sub_u32 v130, v130, v112
    v_cvt_f32_i32 v130, v130
    v_fma_f32 v130, v130, s34, v112
    v_sub_u32 v131, v131, v112
    v_cvt_f32_i32 v131, v131
    v_fma_f32 v131, v131, s34, v112
    v_sub_u32 v132, v132, v112
    v_cvt_f32_i32 v132, v132
    v_fma_f32 v132, v132, s34, v112
    v_sub_u32 v133, v133, v112
    v_cvt_f32_i32 v133, v133
    v_fma_f32 v133, v133, s34, v112
    v_sub_u32 v134, v134, v112
    v_cvt_f32_i32 v134, v134
    v_fma_f32 v134, v134, s34, v112
    v_sub_u32 v135, v135, v112
    v_cvt_f32_i32 v135, v135
    v_fma_f32 v135, v135, s34, v112
    v_sub_u32 v136, v136, v112
    v_cvt_f32_i32 v136, v136
    v_fma_f32 v136, v136, s34, v112
    v_sub_u32 v137, v137, v112
    v_cvt_f32_i32 v137, v137
    v_fma_f32 v137, v137, s34, v112
    v_sub_u32 v138, v138, v112
    v_cvt_f32_i32 v138, v138
    v_fma_f32 v138, v138, s34, v112
    v_sub_u32 v139, v139, v112
    v_cvt_f32_i32 v139, v139
    v_fma_f32 v139, v139, s34, v112
    v_sub_u32 v140, v140, v112
    v_cvt_f32_i32 v140, v140
    v_fma_f32 v140, v140, s34, v112
    v_sub_u32 v141, v141, v112
    v_cvt_f32_i32 v141, v141
    v_fma_f32 v141, v141, s34, v112
    v_sub_u32 v142, v142, v112
    v_cvt_f32_i32 v142, v142
    v_fma_f32 v142, v142, s34, v112
    v_sub_u32 v143, v143, v112
    v_cvt_f32_i32 v143, v143
    v_fma_f32 v143, v143, s34, v112
    v_sub_u32 v144, v144, v112
    v_cvt_f32_i32 v144, v144
    v_fma_f32 v144, v144, s34, v112
    v_sub_u32 v145, v145, v112
    v_cvt_f32_i32 v145, v145
    v_fma_f32 v145, v145, s34, v112
    v_sub_u32 v146, v146, v112
    v_cvt_f32_i32 v146, v146
    v_fma_f32 v146, v146, s34, v112
    v_sub_u32 v147, v147, v112
    v_cvt_f32_i32 v147, v147
    v_fma_f32 v147, v147, s34, v112
    v_sub_u32 v148, v148, v112
    v_cvt_f32_i32 v148, v148
    v_fma_f32 v148, v148, s34, v112
    v_sub_u32 v149, v149, v112
    v_cvt_f32_i32 v149, v149
    v_fma_f32 v149, v149, s34, v112
    v_sub_u32 v150, v150, v112
    v_cvt_f32_i32 v150, v150
    v_fma_f32 v150, v150, s34, v112
    v_sub_u32 v151, v151, v112
    v_cvt_f32_i32 v151, v151
    v_fma_f32 v151, v151, s34, v112
    v_sub_u32 v152, v152, v112
    v_cvt_f32_i32 v152, v152
    v_fma_f32 v152, v152, s34, v112
    v_sub_u32 v153, v153, v112
    v_cvt_f32_i32 v153, v153
    v_fma_f32 v153, v153, s34, v112
    v_sub_u32 v154, v154, v112
    v_cvt_f32_i32 v154, v154
    v_fma_f32 v154, v154, s34, v112
    v_sub_u32 v155, v155, v112
    v_cvt_f32_i32 v155, v155
    v_fma_f32 v155, v155, s34, v112
    v_sub_u32 v156, v156, v112
    v_cvt_f32_i32 v156, v156
    v_fma_f32 v156, v156, s34, v112
    v_sub_u32 v157, v157, v112
    v_cvt_f32_i32 v157, v157
    v_fma_f32 v157, v157, s34, v112
    v_sub_u32 v158, v158, v112
    v_cvt_f32_i32 v158, v158
    v_fma_f32 v158, v158, s34, v112
    v_sub_u32 v159, v159, v112
    v_cvt_f32_i32 v159, v159
    v_fma_f32 v159, v159, s34, v112
    v_sub_u32 v160, v160, v112
    v_cvt_f32_i32 v160, v160
    v_fma_f32 v160, v160, s34, v112
    v_sub_u32 v161, v161, v112
    v_cvt_f32_i32 v161, v161
    v_fma_f32 v161, v161, s34, v112
    v_sub_u32 v162, v162, v112
    v_cvt_f32_i32 v162, v162
    v_fma_f32 v162, v162, s34, v112
    v_sub_u32 v163, v163, v112
    v_cvt_f32_i32 v163, v163
    v_fma_f32 v163, v163, s34, v112
    v_sub_u32 v164, v164, v112
    v_cvt_f32_i32 v164, v164
    v_fma_f32 v164, v164, s34, v112
    v_sub_u32 v165, v165, v112
    v_cvt_f32_i32 v165, v165
    v_fma_f32 v165, v165, s34, v112
    v_sub_u32 v166, v166, v112
    v_cvt_f32_i32 v166, v166
    v_fma_f32 v166, v166, s34, v112
    v_sub_u32 v167, v167, v112
    v_cvt_f32_i32 v167, v167
    v_fma_f32 v167, v167, s34, v112
    v_sub_u32 v168, v168, v112
    v_cvt_f32_i32 v168, v168
    v_fma_f32 v168, v168, s34, v112
    v_sub_u32 v169, v169, v112
    v_cvt_f32_i32 v169, v169
    v_fma_f32 v169, v169, s34, v112
    v_sub_u32 v170, v170, v112
    v_cvt_f32_i32 v170, v170
    v_fma_f32 v170, v170, s34, v112
    v_sub_u32 v171, v171, v112
    v_cvt_f32_i32 v171, v171
    v_fma_f32 v171, v171, s34, v112
    v_sub_u32 v172, v172, v112
    v_cvt_f32_i32 v172, v172
    v_fma_f32 v172, v172, s34, v112
    v_sub_u32 v173, v173, v112
    v_cvt_f32_i32 v173, v173
    v_fma_f32 v173, v173, s34, v112
    v_sub_u32 v174, v174, v112
    v_cvt_f32_i32 v174, v174
    v_fma_f32 v174, v174, s34, v112
    v_sub_u32 v175, v175, v112
    v_cvt_f32_i32 v175, v175
    v_fma_f32 v175, v175, s34, v112
    v_sub_u32 v176, v176, v112
    v_cvt_f32_i32 v176, v176
    v_fma_f32 v176, v176, s34, v112
    v_sub_u32 v177, v177, v112
    v_cvt_f32_i32 v177, v177
    v_fma_f32 v177, v177, s34, v112
    v_sub_u32 v178, v178, v112
    v_cvt_f32_i32 v178, v178
    v_fma_f32 v178, v178, s34, v112
    v_sub_u32 v179, v179, v112
    v_cvt_f32_i32 v179, v179
    v_fma_f32 v179, v179, s34, v112
    v_sub_u32 v180, v180, v112
    v_cvt_f32_i32 v180, v180
    v_fma_f32 v180, v180, s34, v112
    v_sub_u32 v181, v181, v112
    v_cvt_f32_i32 v181, v181
    v_fma_f32 v181, v181, s34, v112
    v_sub_u32 v182, v182, v112
    v_cvt_f32_i32 v182, v182
    v_fma_f32 v182, v182, s34, v112
    v_sub_u32 v183, v183, v112
    v_cvt_f32_i32 v183, v183
    v_fma_f32 v183, v183, s34, v112
    v_sub_u32 v184, v184, v112
    v_cvt_f32_i32 v184, v184
    v_fma_f32 v184, v184, s34, v112
    v_sub_u32 v185, v185, v112
    v_cvt_f32_i32 v185, v185
    v_fma_f32 v185, v185, s34, v112
    v_sub_u32 v186, v186, v112
    v_cvt_f32_i32 v186, v186
    v_fma_f32 v186, v186, s34, v112
    v_sub_u32 v187, v187, v112
    v_cvt_f32_i32 v187, v187
    v_fma_f32 v187, v187, s34, v112
    v_sub_u32 v188, v188, v112
    v_cvt_f32_i32 v188, v188
    v_fma_f32 v188, v188, s34, v112
    v_sub_u32 v189, v189, v112
    v_cvt_f32_i32 v189, v189
    v_fma_f32 v189, v189, s34, v112
    v_sub_u32 v190, v190, v112
    v_cvt_f32_i32 v190, v190
    v_fma_f32 v190, v190, s34, v112
    v_sub_u32 v191, v191, v112
    v_cvt_f32_i32 v191, v191
    v_fma_f32 v191, v191, s34, v112
    v_sub_u32 v192, v192, v112
    v_cvt_f32_i32 v192, v192
    v_fma_f32 v192, v192, s34, v112
    v_sub_u32 v193, v193, v112
    v_cvt_f32_i32 v193, v193
    v_fma_f32 v193, v193, s34, v112
    v_sub_u32 v194, v194, v112
    v_cvt_f32_i32 v194, v194
    v_fma_f32 v194, v194, s34, v112
    v_sub_u32 v195, v195, v112
    v_cvt_f32_i32 v195, v195
    v_fma_f32 v195, v195, s34, v112
    v_sub_u32 v196, v196, v112
    v_cvt_f32_i32 v196, v196
    v_fma_f32 v196, v196, s34, v112
    v_sub_u32 v197, v197, v112
    v_cvt_f32_i32 v197, v197
    v_fma_f32 v197, v197, s34, v112
    v_sub_u32 v198, v198, v112
    v_cvt_f32_i32 v198, v198
    v_fma_f32 v198, v198, s34, v112
    v_sub_u32 v199, v199, v112
    v_cvt_f32_i32 v199, v199
    v_fma_f32 v199, v199, s34, v112
    v_sub_u32 v200, v200, v112
    v_cvt_f32_i32 v200, v200
    v_fma_f32 v200, v200, s34, v112
    v_sub_u32 v201, v201, v112
    v_cvt_f32_i32 v201, v201
    v_fma_f32 v201, v201, s34, v112
    v_sub_u32 v202, v202, v112
    v_cvt_f32_i32 v202, v202
    v_fma_f32 v202, v202, s34, v112
    v_sub_u32 v203, v203, v112
    v_cvt_f32_i32 v203, v203
    v_fma_f32 v203, v203, s34, v112
    v_sub_u32 v204, v204, v112
    v_cvt_f32_i32 v204, v204
    v_fma_f32 v204, v204, s34, v112
    v_sub_u32 v205, v205, v112
    v_cvt_f32_i32 v205, v205
    v_fma_f32 v205, v205, s34, v112
    v_sub_u32 v206, v206, v112
    v_cvt_f32_i32 v206, v206
    v_fma_f32 v206, v206, s34, v112
    v_sub_u32 v207, v207, v112
    v_cvt_f32_i32 v207, v207
    v_fma_f32 v207, v207, s34, v112
    v_sub_u32 v208, v208, v112
    v_cvt_f32_i32 v208, v208
    v_fma_f32 v208, v208, s34, v112
    v_sub_u32 v209, v209, v112
    v_cvt_f32_i32 v209, v209
    v_fma_f32 v209, v209, s34, v112
    v_sub_u32 v210, v210, v112
    v_cvt_f32_i32 v210, v210
    v_fma_f32 v210, v210, s34, v112
    v_sub_u32 v211, v211, v112
    v_cvt_f32_i32 v211, v211
    v_fma_f32 v211, v211, s34, v112
    v_sub_u32 v212, v212, v112
    v_cvt_f32_i32 v212, v212
    v_fma_f32 v212, v212, s34, v112
    v_sub_u32 v213, v213, v112
    v_cvt_f32_i32 v213, v213
    v_fma_f32 v213, v213, s34, v112
    v_sub_u32 v214, v214, v112
    v_cvt_f32_i32 v214, v214
    v_fma_f32 v214, v214, s34, v112
    v_sub_u32 v215, v215, v112
    v_cvt_f32_i32 v215, v215
    v_fma_f32 v215, v215, s34, v112
    v_sub_u32 v216, v216, v112
    v_cvt_f32_i32 v216, v216
    v_fma_f32 v216, v216, s34, v112
    v_sub_u32 v217, v217, v112
    v_cvt_f32_i32 v217, v217
    v_fma_f32 v217, v217, s34, v112
    v_sub_u32 v218, v218, v112
    v_cvt_f32_i32 v218, v218
    v_fma_f32 v218, v218, s34, v112
    v_sub_u32 v219, v219, v112
    v_cvt_f32_i32 v219, v219
    v_fma_f32 v219, v219, s34, v112
    v_sub_u32 v220, v220, v112
    v_cvt_f32_i32 v220, v220
    v_fma_f32 v220, v220, s34, v112
    v_sub_u32 v221, v221, v112
    v_cvt_f32_i32 v221, v221
    v_fma_f32 v221, v221, s34, v112
    v_sub_u32 v222, v222, v112
    v_cvt_f32_i32 v222, v222
    v_fma_f32 v222, v222, s34, v112
    v_sub_u32 v223, v223, v112
    v_cvt_f32_i32 v223, v223
    v_fma_f32 v223, v223, s34, v112
    v_sub_u32 v224, v224, v112
    v_cvt_f32_i32 v224, v224
    v_fma_f32 v224, v224, s34, v112
    v_sub_u32 v225, v225, v112
    v_cvt_f32_i32 v225, v225
    v_fma_f32 v225, v225, s34, v112
    v_sub_u32 v226, v226, v112
    v_cvt_f32_i32 v226, v226
    v_fma_f32 v226, v226, s34, v112
    v_sub_u32 v227, v227, v112
    v_cvt_f32_i32 v227, v227
    v_fma_f32 v227, v227, s34, v112
    v_sub_u32 v228, v228, v112
    v_cvt_f32_i32 v228, v228
    v_fma_f32 v228, v228, s34, v112
    v_sub_u32 v229, v229, v112
    v_cvt_f32_i32 v229, v229
    v_fma_f32 v229, v229, s34, v112
    v_sub_u32 v230, v230, v112
    v_cvt_f32_i32 v230, v230
    v_fma_f32 v230, v230, s34, v112
    v_sub_u32 v231, v231, v112
    v_cvt_f32_i32 v231, v231
    v_fma_f32 v231, v231, s34, v112
    v_fma_f32 v110, v120, v64, v66
    v_fma_f32 v111, v124, v65, v67
    v_cvt_pk_bf16_f32 v92, v110, v111
    v_fma_f32 v110, v121, v64, v66
    v_fma_f32 v111, v125, v65, v67
    v_cvt_pk_bf16_f32 v94, v110, v111
    v_fma_f32 v110, v122, v64, v66
    v_fma_f32 v111, v126, v65, v67
    v_cvt_pk_bf16_f32 v96, v110, v111
    v_fma_f32 v110, v123, v64, v66
    v_fma_f32 v111, v127, v65, v67
    v_cvt_pk_bf16_f32 v98, v110, v111
    v_fma_f32 v110, v128, v64, v66
    v_fma_f32 v111, v132, v65, v67
    v_cvt_pk_bf16_f32 v100, v110, v111
    v_fma_f32 v110, v129, v64, v66
    v_fma_f32 v111, v133, v65, v67
    v_cvt_pk_bf16_f32 v102, v110, v111
    v_fma_f32 v110, v130, v64, v66
    v_fma_f32 v111, v134, v65, v67
    v_cvt_pk_bf16_f32 v104, v110, v111
    v_fma_f32 v110, v131, v64, v66
    v_fma_f32 v111, v135, v65, v67
    v_cvt_pk_bf16_f32 v106, v110, v111
    v_fma_f32 v110, v136, v68, v70
    v_fma_f32 v111, v140, v69, v71
    v_cvt_pk_bf16_f32 v93, v110, v111
    buffer_store_dwordx2 v[92:93], v246, s[28:31], s68 offen offset:0 sc1 nt
    v_fma_f32 v110, v137, v68, v70
    v_fma_f32 v111, v141, v69, v71
    v_cvt_pk_bf16_f32 v95, v110, v111
    buffer_store_dwordx2 v[94:95], v246, s[28:31], s69 offen offset:0 sc1 nt
    v_fma_f32 v110, v138, v68, v70
    v_fma_f32 v111, v142, v69, v71
    v_cvt_pk_bf16_f32 v97, v110, v111
    buffer_store_dwordx2 v[96:97], v246, s[28:31], s70 offen offset:0 sc1 nt
    v_fma_f32 v110, v139, v68, v70
    v_fma_f32 v111, v143, v69, v71
    v_cvt_pk_bf16_f32 v99, v110, v111
    buffer_store_dwordx2 v[98:99], v246, s[28:31], s71 offen offset:0 sc1 nt
    v_fma_f32 v110, v144, v68, v70
    v_fma_f32 v111, v148, v69, v71
    v_cvt_pk_bf16_f32 v101, v110, v111
    buffer_store_dwordx2 v[100:101], v246, s[28:31], s72 offen offset:0 sc1 nt
    v_fma_f32 v110, v145, v68, v70
    v_fma_f32 v111, v149, v69, v71
    v_cvt_pk_bf16_f32 v103, v110, v111
    buffer_store_dwordx2 v[102:103], v246, s[28:31], s73 offen offset:0 sc1 nt
    v_fma_f32 v110, v146, v68, v70
    v_fma_f32 v111, v150, v69, v71
    v_cvt_pk_bf16_f32 v105, v110, v111
    buffer_store_dwordx2 v[104:105], v246, s[28:31], s74 offen offset:0 sc1 nt
    v_fma_f32 v110, v147, v68, v70
    v_fma_f32 v111, v151, v69, v71
    v_cvt_pk_bf16_f32 v107, v110, v111
    buffer_store_dwordx2 v[106:107], v246, s[28:31], s75 offen offset:0 sc1 nt
    s_waitcnt vmcnt(0)
    v_fma_f32 v110, v152, v72, v74
    v_fma_f32 v111, v156, v73, v75
    v_cvt_pk_bf16_f32 v92, v110, v111
    v_fma_f32 v110, v153, v72, v74
    v_fma_f32 v111, v157, v73, v75
    v_cvt_pk_bf16_f32 v94, v110, v111
    v_fma_f32 v110, v154, v72, v74
    v_fma_f32 v111, v158, v73, v75
    v_cvt_pk_bf16_f32 v96, v110, v111
    v_fma_f32 v110, v155, v72, v74
    v_fma_f32 v111, v159, v73, v75
    v_cvt_pk_bf16_f32 v98, v110, v111
    v_fma_f32 v110, v160, v72, v74
    v_fma_f32 v111, v164, v73, v75
    v_cvt_pk_bf16_f32 v100, v110, v111
    v_fma_f32 v110, v161, v72, v74
    v_fma_f32 v111, v165, v73, v75
    v_cvt_pk_bf16_f32 v102, v110, v111
    v_fma_f32 v110, v162, v72, v74
    v_fma_f32 v111, v166, v73, v75
    v_cvt_pk_bf16_f32 v104, v110, v111
    v_fma_f32 v110, v163, v72, v74
    v_fma_f32 v111, v167, v73, v75
    v_cvt_pk_bf16_f32 v106, v110, v111
    v_fma_f32 v110, v168, v76, v78
    v_fma_f32 v111, v172, v77, v79
    v_cvt_pk_bf16_f32 v93, v110, v111
    buffer_store_dwordx2 v[92:93], v246, s[28:31], s68 offen offset:128 sc1 nt
    v_fma_f32 v110, v169, v76, v78
    v_fma_f32 v111, v173, v77, v79
    v_cvt_pk_bf16_f32 v95, v110, v111
    buffer_store_dwordx2 v[94:95], v246, s[28:31], s69 offen offset:128 sc1 nt
    v_fma_f32 v110, v170, v76, v78
    v_fma_f32 v111, v174, v77, v79
    v_cvt_pk_bf16_f32 v97, v110, v111
    buffer_store_dwordx2 v[96:97], v246, s[28:31], s70 offen offset:128 sc1 nt
    v_fma_f32 v110, v171, v76, v78
    v_fma_f32 v111, v175, v77, v79
    v_cvt_pk_bf16_f32 v99, v110, v111
    buffer_store_dwordx2 v[98:99], v246, s[28:31], s71 offen offset:128 sc1 nt
    v_fma_f32 v110, v176, v76, v78
    v_fma_f32 v111, v180, v77, v79
    v_cvt_pk_bf16_f32 v101, v110, v111
    buffer_store_dwordx2 v[100:101], v246, s[28:31], s72 offen offset:128 sc1 nt
    v_fma_f32 v110, v177, v76, v78
    v_fma_f32 v111, v181, v77, v79
    v_cvt_pk_bf16_f32 v103, v110, v111
    buffer_store_dwordx2 v[102:103], v246, s[28:31], s73 offen offset:128 sc1 nt
    v_fma_f32 v110, v178, v76, v78
    v_fma_f32 v111, v182, v77, v79
    v_cvt_pk_bf16_f32 v105, v110, v111
    buffer_store_dwordx2 v[104:105], v246, s[28:31], s74 offen offset:128 sc1 nt
    v_fma_f32 v110, v179, v76, v78
    v_fma_f32 v111, v183, v77, v79
    v_cvt_pk_bf16_f32 v107, v110, v111
    buffer_store_dwordx2 v[106:107], v246, s[28:31], s75 offen offset:128 sc1 nt
    s_waitcnt vmcnt(0)
    v_fma_f32 v110, v184, v80, v82
    v_fma_f32 v111, v188, v81, v83
    v_cvt_pk_bf16_f32 v92, v110, v111
    v_fma_f32 v110, v185, v80, v82
    v_fma_f32 v111, v189, v81, v83
    v_cvt_pk_bf16_f32 v94, v110, v111
    v_fma_f32 v110, v186, v80, v82
    v_fma_f32 v111, v190, v81, v83
    v_cvt_pk_bf16_f32 v96, v110, v111
    v_fma_f32 v110, v187, v80, v82
    v_fma_f32 v111, v191, v81, v83
    v_cvt_pk_bf16_f32 v98, v110, v111
    v_fma_f32 v110, v192, v80, v82
    v_fma_f32 v111, v196, v81, v83
    v_cvt_pk_bf16_f32 v100, v110, v111
    v_fma_f32 v110, v193, v80, v82
    v_fma_f32 v111, v197, v81, v83
    v_cvt_pk_bf16_f32 v102, v110, v111
    v_fma_f32 v110, v194, v80, v82
    v_fma_f32 v111, v198, v81, v83
    v_cvt_pk_bf16_f32 v104, v110, v111
    v_fma_f32 v110, v195, v80, v82
    v_fma_f32 v111, v199, v81, v83
    v_cvt_pk_bf16_f32 v106, v110, v111
    v_fma_f32 v110, v200, v84, v86
    v_fma_f32 v111, v204, v85, v87
    v_cvt_pk_bf16_f32 v93, v110, v111
    buffer_store_dwordx2 v[92:93], v246, s[28:31], s68 offen offset:256 sc1 nt
    v_fma_f32 v110, v201, v84, v86
    v_fma_f32 v111, v205, v85, v87
    v_cvt_pk_bf16_f32 v95, v110, v111
    buffer_store_dwordx2 v[94:95], v246, s[28:31], s69 offen offset:256 sc1 nt
    v_fma_f32 v110, v202, v84, v86
    v_fma_f32 v111, v206, v85, v87
    v_cvt_pk_bf16_f32 v97, v110, v111
    buffer_store_dwordx2 v[96:97], v246, s[28:31], s70 offen offset:256 sc1 nt
    v_fma_f32 v110, v203, v84, v86
    v_fma_f32 v111, v207, v85, v87
    v_cvt_pk_bf16_f32 v99, v110, v111
    buffer_store_dwordx2 v[98:99], v246, s[28:31], s71 offen offset:256 sc1 nt
    v_fma_f32 v110, v208, v84, v86
    v_fma_f32 v111, v212, v85, v87
    v_cvt_pk_bf16_f32 v101, v110, v111
    buffer_store_dwordx2 v[100:101], v246, s[28:31], s72 offen offset:256 sc1 nt
    v_fma_f32 v110, v209, v84, v86
    v_fma_f32 v111, v213, v85, v87
    v_cvt_pk_bf16_f32 v103, v110, v111
    buffer_store_dwordx2 v[102:103], v246, s[28:31], s73 offen offset:256 sc1 nt
    v_fma_f32 v110, v210, v84, v86
    v_fma_f32 v111, v214, v85, v87
    v_cvt_pk_bf16_f32 v105, v110, v111
    buffer_store_dwordx2 v[104:105], v246, s[28:31], s74 offen offset:256 sc1 nt
    v_fma_f32 v110, v211, v84, v86
    v_fma_f32 v111, v215, v85, v87
    v_cvt_pk_bf16_f32 v107, v110, v111
    buffer_store_dwordx2 v[106:107], v246, s[28:31], s75 offen offset:256 sc1 nt
    s_waitcnt vmcnt(0)
    v_fma_f32 v110, v216, v88, v90
    v_fma_f32 v111, v220, v89, v91
    v_cvt_pk_bf16_f32 v92, v110, v111
    buffer_store_dword v92, v247, s[28:31], s68 offen offset:0 sc1 nt
    v_fma_f32 v110, v217, v88, v90
    v_fma_f32 v111, v221, v89, v91
    v_cvt_pk_bf16_f32 v94, v110, v111
    buffer_store_dword v94, v247, s[28:31], s69 offen offset:0 sc1 nt
    v_fma_f32 v110, v218, v88, v90
    v_fma_f32 v111, v222, v89, v91
    v_cvt_pk_bf16_f32 v96, v110, v111
    buffer_store_dword v96, v247, s[28:31], s70 offen offset:0 sc1 nt
    v_fma_f32 v110, v219, v88, v90
    v_fma_f32 v111, v223, v89, v91
    v_cvt_pk_bf16_f32 v98, v110, v111
    buffer_store_dword v98, v247, s[28:31], s71 offen offset:0 sc1 nt
    v_fma_f32 v110, v224, v88, v90
    v_fma_f32 v111, v228, v89, v91
    v_cvt_pk_bf16_f32 v100, v110, v111
    buffer_store_dword v100, v247, s[28:31], s72 offen offset:0 sc1 nt
    v_fma_f32 v110, v225, v88, v90
    v_fma_f32 v111, v229, v89, v91
    v_cvt_pk_bf16_f32 v102, v110, v111
    buffer_store_dword v102, v247, s[28:31], s73 offen offset:0 sc1 nt
    v_fma_f32 v110, v226, v88, v90
    v_fma_f32 v111, v230, v89, v91
    v_cvt_pk_bf16_f32 v104, v110, v111
    buffer_store_dword v104, v247, s[28:31], s74 offen offset:0 sc1 nt
    v_fma_f32 v110, v227, v88, v90
    v_fma_f32 v111, v231, v89, v91
    v_cvt_pk_bf16_f32 v106, v110, v111
    buffer_store_dword v106, v247, s[28:31], s75 offen offset:0 sc1 nt
    s_endpgm
    .fill 256, 4, 0xbf800000
.section .rodata,"a"
.p2align 6
.amdhsa_kernel standalone__w8a8_smoothquant_per_tensor_per_channel_int8_activations_weights__prompt_kernel
  .amdhsa_next_free_vgpr 448
  .amdhsa_next_free_sgpr 102
  .amdhsa_accum_offset 256
  .amdhsa_group_segment_fixed_size 0
  .amdhsa_kernarg_size 72
  .amdhsa_user_sgpr_count 2
  .amdhsa_user_sgpr_kernarg_segment_ptr 1
  .amdhsa_system_sgpr_workgroup_id_x 1
.end_amdhsa_kernel
```

```asm
; @launch grid=(256,1,1) block=(256,1,1) lds=133120
.amdgcn_target "amdgcn-amd-amdhsa--gfx950"
.text
.globl standalone__w8a8_smoothquant_per_tensor_per_channel_int8_activations_weights__prompt_kernel
.p2align 8
.type standalone__w8a8_smoothquant_per_tensor_per_channel_int8_activations_weights__prompt_kernel,@function
standalone__w8a8_smoothquant_per_tensor_per_channel_int8_activations_weights__prompt_kernel:
    s_load_dwordx4 s[4:7], s[0:1], 0
    s_load_dwordx4 s[56:59], s[0:1], 56
    s_memrealtime s[32:33]
    s_cmp_ge_u32 s2, 256
    s_cbranch_scc1 K_END
    v_lshrrev_b32 v1, 6, v0
    v_and_b32 v2, 63, v0
    v_readfirstlane_b32 s3, v1
    s_mov_b32 s14, 14680064
    s_mov_b32 s11, 0x00020000
    s_and_b32 s41, s2, 1
    s_lshl_b32 s41, s41, 3
    s_bfe_u32 s40, s2, 0x30003
    s_add_u32 s41, s41, s40
    s_bfe_u32 s40, s2, 0x20001
    s_lshl_b32 s40, s40, 2
    s_lshr_b32 s42, s2, 6
    s_add_u32 s40, s40, s42
    s_lshl_b32 s44, s40, 4
    s_add_u32 s44, s44, s41
    v_lshrrev_b32 v4, 3, v2
    v_and_b32 v7, 7, v2
    v_lshrrev_b32 v8, 4, v2
    v_mul_u32_u24 v6, 1835008, v8
    v_lshlrev_b32 v5, 12, v4
    v_lshl_add_u32 v5, v7, 4, v5
    v_and_b32 v9, 15, v2
    v_lshl_add_u32 v9, v9, 4, v6
    v_cmp_gt_u32 vcc, 128, v0
    s_and_b32 s47, s3, 1
    s_and_b32 s42, s40, 14
    s_or_b32 s42, s42, s47
    s_lshr_b32 s45, s42, 3
    s_lshl_b32 s45, s45, 7
    s_and_b32 s46, s42, 7
    s_add_u32 s45, s45, s46
    s_mul_i32 s45, s45, 57344
    s_mul_i32 s46, s41, 896
    s_add_u32 s46, s46, 128
    s_and_b32 s46, s46, 0xffffff00
    s_add_u32 s45, s45, s46
    s_and_b32 s46, s40, 1
    s_lshl_b32 s46, s46, 8
    s_add_u32 s45, s45, s46
    s_lshl_b32 s46, s44, 15
    s_lshl_b32 s47, s47, 11
    s_add_u32 s46, s46, s47
    v_cndmask_b32 v5, v9, v5, vcc
    s_mov_b32 s64, 14336
    s_mov_b32 s65, 458752
    s_cmp_lt_u32 s3, 2
    s_cselect_b32 s45, s46, s45
    s_cselect_b32 s64, 512, s64
    s_cselect_b32 s65, 128, s65
    s_cselect_b32 s10, 8388608, s14
    s_waitcnt lgkmcnt(0)
    s_cselect_b64 s[8:9], s[4:5], s[6:7]
    s_mov_b32 s51, s45
    buffer_load_dwordx4 v[16:19], v5, s[8:11], s51 offen nt
    s_add_u32 s51, s51, s64
    buffer_load_dwordx4 v[20:23], v5, s[8:11], s51 offen nt
    s_add_u32 s51, s51, s64
    buffer_load_dwordx4 v[24:27], v5, s[8:11], s51 offen nt
    s_add_u32 s51, s51, s64
    buffer_load_dwordx4 v[28:31], v5, s[8:11], s51 offen nt
    s_mul_i32 s51, s65, 1
    s_add_u32 s51, s51, s45
    buffer_load_dwordx4 v[32:35], v5, s[8:11], s51 offen nt
    s_lshr_b32 s46, s2, 3
    s_or_b32 s46, s46, s3
    s_cbranch_scc1 NOPUB
    s_or_b32 s32, s32, 1
    v_mov_b32 v12, s32
    v_mov_b32 v13, 0
    s_mov_b64 exec, 1
    global_atomic_cmpswap v13, v[12:13], s[56:57] sc1
    s_mov_b64 exec, -1
NOPUB:
    s_mov_b64 s[12:13], s[6:7]
    s_mov_b64 s[16:17], s[58:59]
    s_load_dwordx4 s[4:7], s[0:1], 16
    s_load_dwordx2 s[20:21], s[0:1], 32
    s_load_dwordx2 s[24:25], s[0:1], 40
    s_load_dwordx2 s[28:29], s[0:1], 48
    v_lshlrev_b32 v3, 4, v2
    s_getpc_b64 s[66:67]
CPF_P:
    s_add_u32 s66, s66, PAGE0-CPF_P
    s_addc_u32 s67, s67, 0
    s_bfe_u32 s55, s2, 0x30003
    s_lshl_b32 s55, s55, 2
    s_add_u32 s55, s55, s3
    s_lshl_b32 s55, s55, 9
    v_and_b32 v237, 0x1f0, v3
    v_add_u32 v237, s55, v237
    v_min_u32 v237, K_END-PAGE0+1024, v237
    global_load_dword v237, v237, s[66:67]
    s_mov_b32 s18, 8388608
    s_mov_b32 s19, 0x00020000
    s_add_u32 s52, s41, 16
    s_cmp_lt_u32 s3, 2
    s_cselect_b32 s52, s40, s52
    s_cselect_b32 s53, s41, s40
    s_mul_i32 s52, s52, 4352
    s_lshl_b32 s53, s53, 1
    s_and_b32 s33, s3, 1
    s_add_u32 s53, s53, s33
    s_lshl_b32 s53, s53, 2
    s_add_u32 s52, s52, s53
    s_add_u32 s52, s52, 7340032
    s_mul_i32 s53, s41, 4352
    s_lshl_b32 s33, s40, 2
    s_add_u32 s33, s33, s53
    s_add_u32 s33, s33, 7897088
    v_mov_b32 v232, 0
    v_cmp_gt_u32 vcc, 4, v2
    v_mul_u32_u24 v14, 139264, v2
    v_add_u32 v14, s52, v14
    v_mov_b32 v15, s33
    v_cndmask_b32 v14, v15, v14, vcc
    buffer_load_dword v236, v14, s[16:19], 0 offen sc1
    s_mul_i32 s48, s41, 233472
    s_add_u32 s48, s48, 2097152
    v_and_b32 v11, 1, v8
    v_lshrrev_b32 v10, 1, v8
    s_cmp_lt_u32 s3, 2
    s_cbranch_scc0 IFW0
    v_lshlrev_b32 v9, 8, v7
    v_lshl_add_u32 v9, v4, 4, v9
    s_lshr_b32 s47, s44, 1
    s_lshl_b32 s47, s47, 14
    s_and_b32 s49, s41, 1
    s_lshl_b32 s49, s49, 7
    s_add_u32 s47, s47, s49
    s_lshl_b32 s49, s3, 11
    s_add_u32 s47, s47, s49
    s_lshr_b32 s49, s41, 2
    s_lshl_b32 s49, s49, 12
    s_xor_b32 s47, s47, s49
    s_branch IFE0
IFW0:
    v_and_b32 v9, 15, v2
    v_lshlrev_b32 v9, 4, v9
    v_lshl_add_u32 v9, v10, 8, v9
    v_lshl_add_u32 v9, v11, 15, v9
    s_and_b32 s47, s40, 1
    s_lshl_b32 s47, s47, 16
    s_lshl_b32 s49, s42, 9
    s_add_u32 s47, s47, s49
    v_add_u32 v116, s47, v9
    s_add_u32 s47, s47, s48
IFE0:
    s_mov_b32 s54, 0x01010101
    s_waitcnt vmcnt(6)
    s_add_u32 s51, s51, s64
    buffer_load_dwordx4 v[36:39], v5, s[8:11], s51 offen nt
    s_waitcnt vmcnt(6)
    s_add_u32 s51, s51, s64
    buffer_load_dwordx4 v[40:43], v5, s[8:11], s51 offen nt
    s_waitcnt vmcnt(6)
    s_add_u32 s51, s51, s64
    buffer_load_dwordx4 v[44:47], v5, s[8:11], s51 offen nt
    s_waitcnt vmcnt(6)
    s_mul_i32 s51, s65, 2
    s_add_u32 s51, s51, s45
    buffer_load_dwordx4 v[48:51], v5, s[8:11], s51 offen nt
    s_cmp_lt_u32 s3, 2
    s_cbranch_scc0 IFW1
    v_ashr_pk_i8_i32 v12, v16, v17, 0
    v_ashr_pk_i8_i32 v13, v20, v21, 0
    v_ashr_pk_i8_i32 v14, v24, v25, 0
    v_ashr_pk_i8_i32 v15, v28, v29, 0
    v_ashr_pk_i8_i32 v12, v18, v19, 0 op_sel:[0,0,0,1]
    v_ashr_pk_i8_i32 v13, v22, v23, 0 op_sel:[0,0,0,1]
    v_ashr_pk_i8_i32 v14, v26, v27, 0 op_sel:[0,0,0,1]
    v_ashr_pk_i8_i32 v15, v30, v31, 0 op_sel:[0,0,0,1]
    buffer_store_dwordx4 v[12:15], v9, s[16:19], s47 offen sc1
    s_xor_b32 s47, s47, 4096
    s_nop 1
    s_branch IFE1
IFW1:
    v_ashr_pk_i8_i32 v12, v16, v20, 0
    v_ashr_pk_i8_i32 v13, v18, v22, 0
    v_ashr_pk_i8_i32 v14, v17, v21, 0
    v_ashr_pk_i8_i32 v15, v19, v23, 0
    v_ashr_pk_i8_i32 v12, v24, v28, 0 op_sel:[0,0,0,1]
    v_ashr_pk_i8_i32 v13, v26, v30, 0 op_sel:[0,0,0,1]
    v_ashr_pk_i8_i32 v14, v25, v29, 0 op_sel:[0,0,0,1]
    v_ashr_pk_i8_i32 v15, v27, v31, 0 op_sel:[0,0,0,1]
    s_nop 1
    v_permlane32_swap_b32 v12, v14
    v_permlane32_swap_b32 v13, v15
    s_nop 1
    v_permlane16_swap_b32 v12, v13
    v_permlane16_swap_b32 v14, v15
    buffer_store_dwordx4 v[12:15], v9, s[16:19], s47 offen sc1
    ds_write_b128 v116, v[12:15] offset:0
    s_add_u32 s47, s47, 8192
    v_dot4_i32_i8 v1, v12, s54, 0
    v_dot4_i32_i8 v1, v13, s54, v1
    v_dot4_i32_i8 v1, v14, s54, v1
    v_dot4_i32_i8 v1, v15, s54, v1
IFE1:
    s_waitcnt vmcnt(7)
    global_load_dword v235, v232, s[56:57] sc1
    s_add_u32 s51, s51, s64
    buffer_load_dwordx4 v[52:55], v5, s[8:11], s51 offen nt
    s_waitcnt lgkmcnt(0)
    s_mov_b32 s15, 0x00020000
    s_mov_b32 s22, 7168
    s_mov_b32 s23, 0x00020000
    s_mov_b32 s26, 7168
    s_mov_b32 s27, 0x00020000
    v_lshl_add_u32 v112, v11, 1, v10
    v_and_b32 v113, 15, v2
    v_lshl_add_u32 v113, v113, 2, v112
    s_lshl_b32 s55, s3, 6
    v_add_u32 v240, s55, v113
    s_and_b32 s55, s41, 1
    s_lshl_b32 s55, s55, 5
    v_add_u32 v114, s55, v240
    v_subrev_u32 v115, 224, v114
    v_min_u32 v114, v114, v115
    s_mul_i32 s55, s41, 448
    v_lshl_add_u32 v114, v114, 1, s55
    buffer_load_ushort v238, v114, s[20:23], 0 offen
    buffer_load_ushort v239, v114, s[24:27], 0 offen
    s_load_dword s34, s[4:5], 0
    s_load_dword s35, s[6:7], 0
    s_add_u32 s36, s16, s48
    s_addc_u32 s37, s17, 0
    s_mov_b32 s38, 229376
    s_mov_b32 s39, 0x00020000
    v_lshrrev_b32 v234, 2, v2
    v_lshl_add_u32 v234, v234, 2, s53
    s_cmp_eq_u32 s3, 3
    s_cselect_b32 s33, s33, 1073741824
    s_add_u32 s53, s53, 69504
    v_lshl_add_u32 v114, v2, 2, s53
    s_mul_i32 s53, s40, 4352
    v_cmp_gt_u32 vcc, 32, v2
    v_lshl_add_u32 v233, v2, 2, s53
    s_mov_b32 s53, 7340032
    v_cndmask_b32 v233, v114, v233, vcc
    s_cmp_eq_u32 s3, 3
    s_cselect_b32 s55, 1073741824, 0
    s_bfe_u32 s46, s40, 0x10002
    s_mul_i32 s46, s46, 64
    s_lshr_b32 s50, s40, 3
    s_mul_i32 s50, s50, 4
    s_add_u32 s46, s46, s50
    s_and_b32 s50, s40, 3
    s_add_u32 s46, s46, s50
    s_mul_i32 s46, s46, 114688
    s_mul_i32 s50, s41, 896
    s_add_u32 s46, s46, s50
    s_lshl_b32 s42, s3, 7
    s_add_u32 s42, s42, 512
    s_and_b32 s50, s41, 1
    s_lshl_b32 s50, s50, 7
    s_add_u32 s50, s50, s42
    s_cmp_ge_u32 s50, 896
    s_cselect_b32 s50, 0, s50
    s_add_u32 s46, s46, s50
    s_or_b32 s46, s46, s55
    v_and_b32 v114, 1, v4
    v_mul_u32_u24 v115, 57344, v114
    v_add_u32 v6, v6, v115
    v_lshl_add_u32 v6, v7, 4, v6
    v_lshlrev_b32 v10, 8, v10
    v_lshl_add_u32 v10, v114, 9, v10
    v_lshl_add_u32 v115, v7, 5, v10
    v_lshl_add_u32 v115, v11, 4, v115
    v_lshl_add_u32 v10, v7, 4, v10
    v_cmp_gt_u32 vcc, 128, v0
    v_lshl_add_u32 v10, v11, 15, v10
    s_lshl_b32 s49, s3, 7
    v_cndmask_b32 v10, v115, v10, vcc
    s_cmp_lt_u32 s3, 2
    s_cselect_b32 s49, s49, 65536
    s_add_u32 s48, s48, s49
    s_lshl_b32 s49, s40, 10
    s_add_u32 s48, s48, s49
    s_add_u32 s48, s48, 131072
    s_or_b32 s48, s48, s55
    v_lshlrev_b32 v8, 1, v113
    v_and_b32 v11, 0x3f, v8
    s_lshl_b32 s50, s41, 4
    s_add_u32 s50, s50, s40
    s_lshl_b32 s50, s50, 9
    s_add_u32 s50, s50, 6291456
    s_lshr_b32 s42, s42, 1
    s_and_b32 s49, s3, 1
    s_lshl_b32 s49, s49, 9
    s_and_b32 s55, s40, 1
    s_mul_i32 s55, s55, 384
    s_sub_u32 s49, s49, s55
    s_add_u32 s49, s49, s50
    s_cmp_lt_u32 s3, 2
    s_cselect_b32 s49, 1073741824, s49
    s_add_u32 s50, s50, s42
    s_waitcnt vmcnt(8)
    s_add_u32 s51, s51, s64
    buffer_load_dwordx4 v[56:59], v5, s[8:11], s51 offen nt
    s_waitcnt vmcnt(8)
    s_add_u32 s51, s51, s64
    buffer_load_dwordx4 v[60:63], v5, s[8:11], s51 offen nt
    s_waitcnt vmcnt(8)
    s_mul_i32 s51, s65, 3
    s_add_u32 s51, s51, s45
    buffer_load_dwordx4 v[64:67], v5, s[8:11], s51 offen nt
    s_cmp_lt_u32 s3, 2
    s_cbranch_scc0 IFW2
    v_ashr_pk_i8_i32 v12, v32, v33, 0
    v_ashr_pk_i8_i32 v13, v36, v37, 0
    v_ashr_pk_i8_i32 v14, v40, v41, 0
    v_ashr_pk_i8_i32 v15, v44, v45, 0
    v_ashr_pk_i8_i32 v12, v34, v35, 0 op_sel:[0,0,0,1]
    v_ashr_pk_i8_i32 v13, v38, v39, 0 op_sel:[0,0,0,1]
    v_ashr_pk_i8_i32 v14, v42, v43, 0 op_sel:[0,0,0,1]
    v_ashr_pk_i8_i32 v15, v46, v47, 0 op_sel:[0,0,0,1]
    buffer_store_dwordx4 v[12:15], v9, s[16:19], s47 offen sc1
    s_xor_b32 s47, s47, 12288
    s_nop 1
    s_branch IFE2
IFW2:
    v_ashr_pk_i8_i32 v12, v32, v36, 0
    v_ashr_pk_i8_i32 v13, v34, v38, 0
    v_ashr_pk_i8_i32 v14, v33, v37, 0
    v_ashr_pk_i8_i32 v15, v35, v39, 0
    v_ashr_pk_i8_i32 v12, v40, v44, 0 op_sel:[0,0,0,1]
    v_ashr_pk_i8_i32 v13, v42, v46, 0 op_sel:[0,0,0,1]
    v_ashr_pk_i8_i32 v14, v41, v45, 0 op_sel:[0,0,0,1]
    v_ashr_pk_i8_i32 v15, v43, v47, 0 op_sel:[0,0,0,1]
    s_nop 1
    v_permlane32_swap_b32 v12, v14
    v_permlane32_swap_b32 v13, v15
    s_nop 1
    v_permlane16_swap_b32 v12, v13
    v_permlane16_swap_b32 v14, v15
    buffer_store_dwordx4 v[12:15], v9, s[16:19], s47 offen sc1
    ds_write_b128 v116, v[12:15] offset:8192
    s_add_u32 s47, s47, 8192
    v_dot4_i32_i8 v1, v12, s54, v1
    v_dot4_i32_i8 v1, v13, s54, v1
    v_dot4_i32_i8 v1, v14, s54, v1
    v_dot4_i32_i8 v1, v15, s54, v1
IFE2:
    s_waitcnt vmcnt(9)
    s_add_u32 s51, s51, s64
    buffer_load_dwordx4 v[68:71], v5, s[8:11], s51 offen nt
    s_waitcnt vmcnt(7)
    v_readfirstlane_b32 s43, v235
    s_mov_b32 s55, 200000
    s_cmp_lg_u32 s43, 0
    s_cbranch_scc1 TAG_OK
TAG_RETRY:
    global_load_dword v235, v232, s[56:57] sc1
    s_sub_u32 s55, s55, 1
    s_waitcnt vmcnt(0)
    v_readfirstlane_b32 s43, v235
    s_cmp_eq_u32 s55, 0
    s_cbranch_scc1 TAG_OK
    s_cmp_eq_u32 s43, 0
    s_cbranch_scc1 TAG_RETRY
TAG_OK:
    s_cmp_eq_u32 s3, 3
    s_cselect_b32 s43, s43, 0
    s_cselect_b32 s53, s53, 1073741824
    s_mov_b64 exec, 1
    buffer_store_dword v235, v232, s[16:19], s52 offen sc1
    s_mov_b64 exec, -1
    s_add_u32 s52, s52, 139264
    s_add_u32 s51, s51, s64
    buffer_load_dwordx4 v[72:75], v5, s[8:11], s51 offen nt
    s_mov_b32 s30, 14680064
    s_mov_b32 s31, 0x00020000
    s_lshl_b32 s42, s40, 2
    s_add_u32 s42, s42, s3
    s_lshl_b32 s62, s42, 15
    s_lshl_b32 s61, s3, 12
    s_add_u32 s62, s62, s61
    s_add_u32 s63, s62, 16384
    s_lshl_b32 s60, s3, 10
    s_lshr_b32 s4, s40, 3
    s_lshl_b32 s4, s4, 1
    s_and_b32 s5, s40, 1
    s_add_u32 s55, s4, s5
    s_bfe_u32 s4, s40, 0x20001
    s_cmp_eq_u32 s4, s3
    s_cselect_b32 s55, s55, 9
    s_cmp_eq_u32 s55, 0
    s_cselect_b32 s4, 133120, s60
    s_cmp_eq_u32 s55, 1
    s_cselect_b32 s5, 133120, s60
    s_cmp_eq_u32 s55, 2
    s_cselect_b32 s6, 133120, s60
    s_cmp_eq_u32 s55, 3
    s_cselect_b32 s7, 133120, s60
    v_lshrrev_b32 v112, 4, v2
    v_and_b32 v113, 15, v2
    v_lshlrev_b32 v244, 9, v112
    v_lshl_add_u32 v244, v113, 4, v244
    v_add_u32 v245, 65536, v244
    v_mul_u32_u24 v246, 28672, v112
    v_lshl_add_u32 v247, v113, 2, v246
    v_lshl_add_u32 v246, v113, 3, v246
    s_and_b32 s55, s41, 1
    s_cselect_b32 s55, 64, 0
    v_add_u32 v246, s55, v246
    v_add_u32 v254, s55, v247
    s_cselect_b32 s55, 0, 384
    v_add_u32 v247, s55, v247
    s_mov_b32 s55, 131072
    v_lshl_add_u32 v248, v113, 2, s55
    v_lshrrev_b32 v114, 1, v113
    v_lshl_add_u32 v249, v114, 2, s55
    v_and_b32 v114, 1, v113
    v_lshl_add_u32 v249, v114, 6, v249
    v_lshl_add_u32 v250, v0, 2, s55
    v_lshlrev_b32 v251, 11, v112
    v_lshl_add_u32 v251, v113, 3, v251
    s_lshl_b32 s32, s41, 13
    s_lshl_b32 s55, s3, 7
    s_add_u32 s32, s32, s55
    s_add_u32 s32, s32, 6291456
    s_mul_i32 s68, s42, 229376
    s_mul_i32 s55, s41, 448
    s_add_u32 s68, s68, s55
    s_add_u32 s69, s68, 7168
    s_add_u32 s70, s68, 14336
    s_add_u32 s71, s68, 21504
    s_add_u32 s72, s68, 114688
    s_add_u32 s73, s68, 121856
    s_add_u32 s74, s68, 129024
    s_add_u32 s75, s68, 136192
    s_branch PAGE0
.p2align 12
PAGE0:
    s_waitcnt vmcnt(6)
    s_add_u32 s51, s51, s64
    buffer_load_dwordx4 v[76:79], v5, s[8:11], s51 offen nt
    s_waitcnt vmcnt(6)
    s_add_u32 s51, s46, 0
    buffer_load_dwordx4 v[80:83], v6, s[12:15], s51 offen nt
    s_cmp_lt_u32 s3, 2
    s_cbranch_scc0 IFW3
    v_ashr_pk_i8_i32 v12, v48, v49, 0
    v_ashr_pk_i8_i32 v13, v52, v53, 0
    v_ashr_pk_i8_i32 v14, v56, v57, 0
    v_ashr_pk_i8_i32 v15, v60, v61, 0
    v_ashr_pk_i8_i32 v12, v50, v51, 0 op_sel:[0,0,0,1]
    v_ashr_pk_i8_i32 v13, v54, v55, 0 op_sel:[0,0,0,1]
    v_ashr_pk_i8_i32 v14, v58, v59, 0 op_sel:[0,0,0,1]
    v_ashr_pk_i8_i32 v15, v62, v63, 0 op_sel:[0,0,0,1]
    buffer_store_dwordx4 v[12:15], v9, s[16:19], s47 offen sc1
    s_xor_b32 s47, s47, 4096
    s_nop 1
    s_branch IFE3
IFW3:
    v_ashr_pk_i8_i32 v12, v48, v52, 0
    v_ashr_pk_i8_i32 v13, v50, v54, 0
    v_ashr_pk_i8_i32 v14, v49, v53, 0
    v_ashr_pk_i8_i32 v15, v51, v55, 0
    v_ashr_pk_i8_i32 v12, v56, v60, 0 op_sel:[0,0,0,1]
    v_ashr_pk_i8_i32 v13, v58, v62, 0 op_sel:[0,0,0,1]
    v_ashr_pk_i8_i32 v14, v57, v61, 0 op_sel:[0,0,0,1]
    v_ashr_pk_i8_i32 v15, v59, v63, 0 op_sel:[0,0,0,1]
    s_nop 1
    v_permlane32_swap_b32 v12, v14
    v_permlane32_swap_b32 v13, v15
    s_nop 1
    v_permlane16_swap_b32 v12, v13
    v_permlane16_swap_b32 v14, v15
    buffer_store_dwordx4 v[12:15], v9, s[16:19], s47 offen sc1
    ds_write_b128 v116, v[12:15] offset:16384
    s_add_u32 s47, s47, 8192
    v_dot4_i32_i8 v1, v12, s54, v1
    v_dot4_i32_i8 v1, v13, s54, v1
    v_dot4_i32_i8 v1, v14, s54, v1
    v_dot4_i32_i8 v1, v15, s54, v1
IFE3:
    s_waitcnt vmcnt(7)
    s_add_u32 s51, s46, 14336
    buffer_load_dwordx4 v[84:87], v6, s[12:15], s51 offen nt
    s_waitcnt vmcnt(6)
    s_mov_b64 exec, 1
    buffer_store_dword v235, v232, s[16:19], s52 offen sc1
    s_mov_b64 exec, -1
    s_add_u32 s52, s52, 139264
    s_add_u32 s51, s46, 28672
    buffer_load_dwordx4 v[88:91], v6, s[12:15], s51 offen nt
    s_waitcnt vmcnt(6)
    s_add_u32 s51, s46, 43008
    buffer_load_dwordx4 v[92:95], v6, s[12:15], s51 offen nt
    s_waitcnt lgkmcnt(0)
    s_lshl_b32 s34, s34, 16
    v_cvt_f32_i32 v252, s35
    v_lshlrev_b32 v238, 16, v238
    v_lshlrev_b32 v239, 16, v239
    v_mul_f32 v238, s34, v238
    v_cvt_pk_bf16_f32 v252, v252, v252
    v_lshlrev_b32 v252, 16, v252
    v_mul_f32 v112, 0x4a800000, v238
    ds_write_b32 v250, v112
    s_mov_b32 s34, 0xcb400000
    s_cmp_lt_u32 s3, 2
    s_cselect_b32 s35, 1073741824, s32
    s_cselect_b32 s32, s32, 1073741824
    s_cselect_b32 s64, 0, s34
    s_cselect_b32 s34, s34, 0
    s_waitcnt lgkmcnt(0)
    v_mov_b32 v112, 0x40400000
    v_mov_b32 v113, 0x40400000
    v_mov_b32 v114, 0x40400000
    v_mov_b32 v115, 0x40400000
    s_mov_b64 vcc, -1
    s_branch ISL1
WARMRET:
    buffer_load_dword v236, v233, s[16:19], s53 offen sc1
    s_waitcnt vmcnt(7)
    s_add_u32 s51, s46, 917504
    buffer_load_dwordx4 v[96:99], v6, s[12:15], s51 offen nt
    buffer_load_dword v231, v233, s[16:19], s53 offen sc1
    s_cmp_lt_u32 s3, 2
    s_cbranch_scc0 IFW4
    v_ashr_pk_i8_i32 v12, v64, v65, 0
    v_ashr_pk_i8_i32 v13, v68, v69, 0
    v_ashr_pk_i8_i32 v14, v72, v73, 0
    v_ashr_pk_i8_i32 v15, v76, v77, 0
    v_ashr_pk_i8_i32 v12, v66, v67, 0 op_sel:[0,0,0,1]
    v_ashr_pk_i8_i32 v13, v70, v71, 0 op_sel:[0,0,0,1]
    v_ashr_pk_i8_i32 v14, v74, v75, 0 op_sel:[0,0,0,1]
    v_ashr_pk_i8_i32 v15, v78, v79, 0 op_sel:[0,0,0,1]
    buffer_store_dwordx4 v[12:15], v9, s[16:19], s47 offen sc1
    s_nop 1
    s_branch IFE4
IFW4:
    v_ashr_pk_i8_i32 v12, v64, v68, 0
    v_ashr_pk_i8_i32 v13, v66, v70, 0
    v_ashr_pk_i8_i32 v14, v65, v69, 0
    v_ashr_pk_i8_i32 v15, v67, v71, 0
    v_ashr_pk_i8_i32 v12, v72, v76, 0 op_sel:[0,0,0,1]
    v_ashr_pk_i8_i32 v13, v74, v78, 0 op_sel:[0,0,0,1]
    v_ashr_pk_i8_i32 v14, v73, v77, 0 op_sel:[0,0,0,1]
    v_ashr_pk_i8_i32 v15, v75, v79, 0 op_sel:[0,0,0,1]
    s_nop 1
    v_permlane32_swap_b32 v12, v14
    v_permlane32_swap_b32 v13, v15
    s_nop 1
    v_permlane16_swap_b32 v12, v13
    v_permlane16_swap_b32 v14, v15
    buffer_store_dwordx4 v[12:15], v9, s[16:19], s47 offen sc1
    ds_write_b128 v116, v[12:15] offset:24576
    s_add_u32 s47, s47, 8192
    v_dot4_i32_i8 v1, v12, s54, v1
    v_dot4_i32_i8 v1, v13, s54, v1
    v_dot4_i32_i8 v1, v14, s54, v1
    v_dot4_i32_i8 v1, v15, s54, v1
IFE4:
    s_nop 2
    buffer_store_short v1, v8, s[16:19], s49 offen sc1
    s_cmp_eq_u32 s3, 3
    s_cbranch_scc0 BP_A
    s_waitcnt vmcnt(4)
    s_mov_b64 exec, 1
    buffer_store_dword v235, v232, s[16:19], s52 offen sc1
    s_mov_b64 exec, -1
    s_add_u32 s52, s52, 139264
    v_cmp_ne_u32 vcc, s43, v236
    s_cbranch_vccz BP_M
    s_waitcnt vmcnt(3)
    v_cmp_ne_u32 vcc, s43, v231
    s_cbranch_vccz BP_M
    s_mov_b32 s55, 200000
PO0_RETRY:
    s_sleep 1
    buffer_load_dword v236, v233, s[16:19], s53 offen sc1
    s_sub_u32 s55, s55, 1
    s_cmp_eq_u32 s55, 0
    s_cbranch_scc1 PO0_OUT
    s_waitcnt vmcnt(0)
    v_cmp_ne_u32 vcc, s43, v236
    s_nop 0
    s_cmp_lg_u64 vcc, 0
    s_cbranch_scc1 PO0_RETRY
PO0_OUT:
    s_branch BP_M
BP_A:
    s_waitcnt vmcnt(10)
    s_add_u32 s51, s46, 931840
    buffer_load_dwordx4 v[100:103], v6, s[12:15], s51 offen nt
    s_waitcnt vmcnt(9)
    s_mov_b64 exec, 1
    buffer_store_dword v235, v232, s[16:19], s52 offen sc1
    s_mov_b64 exec, -1
    s_add_u32 s52, s52, 139264
    s_add_u32 s51, s46, 946176
    buffer_load_dwordx4 v[104:107], v6, s[12:15], s51 offen nt
    s_waitcnt vmcnt(9)
    s_add_u32 s51, s46, 960512
    buffer_load_dwordx4 v[108:111], v6, s[12:15], s51 offen nt
BP_M:
    s_mov_b64 vcc, 0
PO0_OK:
    s_barrier
    s_add_u32 m0, s4, 0
    s_nop 0
    buffer_load_dwordx4 v3, s[36:39], m0 offen sc1 lds
    s_add_u32 m0, s4, 32768
    s_nop 0
    buffer_load_dwordx4 v3, s[36:39], m0 offen sc1 lds
    s_add_u32 m0, s5, 65536
    s_nop 0
    buffer_load_dwordx4 v3, s[36:39], m0 offen sc1 lds
    s_add_u32 m0, s5, 98304
    s_nop 0
    buffer_load_dwordx4 v3, s[36:39], m0 offen sc1 lds
    buffer_load_dwordx4 a[0:3], v3, s[16:19], s62 offen offset:0 sc1
    buffer_load_dwordx4 a[64:67], v3, s[16:19], s63 offen offset:0 sc1
    buffer_load_dwordx4 a[4:7], v3, s[16:19], s62 offen offset:1024 sc1
    buffer_load_dwordx4 a[68:71], v3, s[16:19], s63 offen offset:1024 sc1
    s_add_u32 s53, s53, 139264
    buffer_load_dword v236, v233, s[16:19], s53 offen sc1
    s_waitcnt vmcnt(18)
    v_ashr_pk_i8_i32 v216, v80, v84, 0
    v_ashr_pk_i8_i32 v217, v82, v86, 0
    v_ashr_pk_i8_i32 v218, v81, v85, 0
    v_ashr_pk_i8_i32 v219, v83, v87, 0
    v_ashr_pk_i8_i32 v216, v88, v92, 0 op_sel:[0,0,0,1]
    v_ashr_pk_i8_i32 v217, v90, v94, 0 op_sel:[0,0,0,1]
    v_ashr_pk_i8_i32 v218, v89, v93, 0 op_sel:[0,0,0,1]
    v_ashr_pk_i8_i32 v219, v91, v95, 0 op_sel:[0,0,0,1]
    s_nop 1
    v_permlane32_swap_b32 v216, v218
    v_permlane32_swap_b32 v217, v219
    s_nop 1
    v_permlane16_swap_b32 v216, v217
    v_permlane16_swap_b32 v218, v219
    v_dot4_i32_i8 v1, v216, s54, 0
    v_dot4_i32_i8 v1, v217, s54, v1
    v_dot4_i32_i8 v1, v218, s54, v1
    v_dot4_i32_i8 v1, v219, s54, v1
    s_add_u32 m0, s6, 4096
    s_nop 0
    buffer_load_dwordx4 v3, s[36:39], m0 offen sc1 lds
    s_add_u32 m0, s6, 36864
    s_nop 0
    buffer_load_dwordx4 v3, s[36:39], m0 offen sc1 lds
    s_add_u32 m0, s7, 69632
    s_nop 0
    buffer_load_dwordx4 v3, s[36:39], m0 offen sc1 lds
    s_add_u32 m0, s7, 102400
    s_nop 0
    buffer_load_dwordx4 v3, s[36:39], m0 offen sc1 lds
    s_waitcnt vmcnt(13)
    v_ashr_pk_i8_i32 v220, v96, v100, 0
    v_ashr_pk_i8_i32 v221, v98, v102, 0
    v_ashr_pk_i8_i32 v222, v97, v101, 0
    v_ashr_pk_i8_i32 v223, v99, v103, 0
    v_ashr_pk_i8_i32 v220, v104, v108, 0 op_sel:[0,0,0,1]
    v_ashr_pk_i8_i32 v221, v106, v110, 0 op_sel:[0,0,0,1]
    v_ashr_pk_i8_i32 v222, v105, v109, 0 op_sel:[0,0,0,1]
    v_ashr_pk_i8_i32 v223, v107, v111, 0 op_sel:[0,0,0,1]
    s_nop 1
    v_permlane32_swap_b32 v220, v222
    v_permlane32_swap_b32 v221, v223
    s_nop 1
    v_permlane16_swap_b32 v220, v221
    v_permlane16_swap_b32 v222, v223
    v_dot4_i32_i8 v1, v220, s54, v1
    v_dot4_i32_i8 v1, v221, s54, v1
    v_dot4_i32_i8 v1, v222, s54, v1
    v_dot4_i32_i8 v1, v223, s54, v1
    s_nop 2
    v_add_u32_dpp v1, v1, v1 row_ror:8 row_mask:0xf bank_mask:0xf
    buffer_load_dwordx4 a[8:11], v3, s[16:19], s62 offen offset:2048 sc1
    buffer_load_dwordx4 a[72:75], v3, s[16:19], s63 offen offset:2048 sc1
    buffer_load_dwordx4 a[12:15], v3, s[16:19], s62 offen offset:3072 sc1
    buffer_load_dwordx4 a[76:79], v3, s[16:19], s63 offen offset:3072 sc1
    s_getpc_b64 s[66:67]
CPF_C:
    s_bfe_u32 s55, s2, 0x30003
    s_lshl_b32 s55, s55, 2
    s_add_u32 s55, s55, s3
    s_lshl_b32 s55, s55, 9
    v_and_b32 v237, 0x1f0, v3
    v_add_u32 v237, s55, v237
    v_min_u32 v237, K_END-CPF_C+1024, v237
    global_load_dword v237, v237, s[66:67]
    s_mov_b64 exec, 1
    buffer_store_dword v235, v232, s[16:19], s52 offen sc1
    s_mov_b64 exec, -1
    s_waitcnt vmcnt(10)
    s_waitcnt lgkmcnt(0)
    v_cmp_ne_u32 vcc, s43, v236
    s_cbranch_vccnz PO1_SLOW
PO1_OK:
    s_barrier
    ds_read_b128 v[16:19], v244 offset:0
    ds_read_b128 v[20:23], v244 offset:256
    ds_read_b128 v[24:27], v244 offset:32768
    ds_read_b128 v[28:31], v244 offset:33024
    ds_read_b128 v[32:35], v245 offset:0
    ds_read_b128 v[36:39], v245 offset:256
    ds_read_b128 v[40:43], v245 offset:32768
    s_waitcnt lgkmcnt(3)
    v_mfma_i32_16x16x64_i8 v[120:123], a[0:3], v[16:19], v[112:115]
    buffer_store_dwordx4 v[216:219], v10, s[16:19], s48 offen sc1
    v_mfma_i32_16x16x64_i8 v[128:131], a[64:67], v[16:19], v[112:115]
    ds_read_b128 v[44:47], v245 offset:33024
    s_add_u32 s48, s48, 16384
    v_mfma_i32_16x16x64_i8 v[124:127], a[0:3], v[20:23], v[112:115]
    buffer_store_dwordx4 v[220:223], v10, s[16:19], s48 offen sc1
    v_mfma_i32_16x16x64_i8 v[132:135], a[64:67], v[20:23], v[112:115]
    ds_read_b128 v[48:51], v244 offset:2048
    v_mfma_i32_16x16x64_i8 v[136:139], a[0:3], v[24:27], v[112:115]
    buffer_store_short v1, v11, s[16:19], s50 offen sc1
    v_mfma_i32_16x16x64_i8 v[144:147], a[64:67], v[24:27], v[112:115]
    ds_read_b128 v[52:55], v244 offset:2304
    s_add_u32 m0, s4, 8192
    v_mfma_i32_16x16x64_i8 v[140:143], a[0:3], v[28:31], v[112:115]
    buffer_load_dwordx4 v3, s[36:39], m0 offen sc1 lds
    v_mfma_i32_16x16x64_i8 v[148:151], a[64:67], v[28:31], v[112:115]
    ds_read_b128 v[56:59], v244 offset:34816
    s_waitcnt lgkmcnt(3)
    v_mfma_i32_16x16x64_i8 v[152:155], a[0:3], v[32:35], v[112:115]
    s_add_u32 m0, s4, 40960
    v_mfma_i32_16x16x64_i8 v[160:163], a[64:67], v[32:35], v[112:115]
    ds_read_b128 v[60:63], v244 offset:35072
    v_mfma_i32_16x16x64_i8 v[156:159], a[0:3], v[36:39], v[112:115]
    buffer_load_dwordx4 v3, s[36:39], m0 offen sc1 lds
    v_mfma_i32_16x16x64_i8 v[164:167], a[64:67], v[36:39], v[112:115]
    ds_read_b128 v[16:19], v245 offset:2048
    s_add_u32 m0, s5, 73728
    v_mfma_i32_16x16x64_i8 v[168:171], a[0:3], v[40:43], v[112:115]
    buffer_load_dwordx4 v3, s[36:39], m0 offen sc1 lds
    v_mfma_i32_16x16x64_i8 v[176:179], a[64:67], v[40:43], v[112:115]
    ds_read_b128 v[20:23], v245 offset:2304
    s_add_u32 m0, s5, 106496
    v_mfma_i32_16x16x64_i8 v[172:175], a[0:3], v[44:47], v[112:115]
    buffer_load_dwordx4 v3, s[36:39], m0 offen sc1 lds
    v_mfma_i32_16x16x64_i8 v[180:183], a[64:67], v[44:47], v[112:115]
    ds_read_b128 v[24:27], v245 offset:34816
    s_waitcnt lgkmcnt(3)
    v_mfma_i32_16x16x64_i8 v[120:123], a[4:7], v[48:51], v[120:123]
    s_add_u32 s53, s53, 139264
    buffer_load_dword v236, v233, s[16:19], s53 offen sc1
    s_xor_b32 s62, s62, 4096
    v_mfma_i32_16x16x64_i8 v[128:131], a[68:71], v[48:51], v[128:131]
    ds_read_b128 v[28:31], v245 offset:35072
    v_mfma_i32_16x16x64_i8 v[124:127], a[4:7], v[52:55], v[124:127]
    buffer_load_dwordx4 a[16:19], v3, s[16:19], s62 offen offset:0 sc1
    v_mfma_i32_16x16x64_i8 v[132:135], a[68:71], v[52:55], v[132:135]
    s_waitcnt vmcnt(15)
    s_barrier
    ds_read_b128 v[32:35], v244 offset:4096
    v_mfma_i32_16x16x64_i8 v[136:139], a[4:7], v[56:59], v[136:139]
    s_xor_b32 s63, s63, 4096
    v_mfma_i32_16x16x64_i8 v[144:147], a[68:71], v[56:59], v[144:147]
    ds_read_b128 v[36:39], v244 offset:4352
    v_mfma_i32_16x16x64_i8 v[140:143], a[4:7], v[60:63], v[140:143]
    buffer_load_dwordx4 a[80:83], v3, s[16:19], s63 offen offset:0 sc1
    v_mfma_i32_16x16x64_i8 v[148:151], a[68:71], v[60:63], v[148:151]
    ds_read_b128 v[40:43], v244 offset:36864
    s_waitcnt lgkmcnt(3)
    v_mfma_i32_16x16x64_i8 v[152:155], a[4:7], v[16:19], v[152:155]
    buffer_load_dwordx4 a[20:23], v3, s[16:19], s62 offen offset:1024 sc1
    v_mfma_i32_16x16x64_i8 v[160:163], a[68:71], v[16:19], v[160:163]
    ds_read_b128 v[44:47], v244 offset:37120
    v_mfma_i32_16x16x64_i8 v[156:159], a[4:7], v[20:23], v[156:159]
    buffer_load_dwordx4 a[84:87], v3, s[16:19], s63 offen offset:1024 sc1
    v_mfma_i32_16x16x64_i8 v[164:167], a[68:71], v[20:23], v[164:167]
    ds_read_b128 v[48:51], v245 offset:4096
    s_add_u32 m0, s6, 12288
    v_mfma_i32_16x16x64_i8 v[168:171], a[4:7], v[24:27], v[168:171]
    buffer_load_dwordx4 v3, s[36:39], m0 offen sc1 lds
    v_mfma_i32_16x16x64_i8 v[176:179], a[68:71], v[24:27], v[176:179]
    ds_read_b128 v[52:55], v245 offset:4352
    s_add_u32 m0, s6, 45056
    v_mfma_i32_16x16x64_i8 v[172:175], a[4:7], v[28:31], v[172:175]
    v_mfma_i32_16x16x64_i8 v[180:183], a[68:71], v[28:31], v[180:183]
    ds_read_b128 v[56:59], v245 offset:36864
    s_waitcnt vmcnt(17) lgkmcnt(3)
    v_mfma_i32_16x16x64_i8 v[120:123], a[8:11], v[32:35], v[120:123]
    buffer_load_dwordx4 v3, s[36:39], m0 offen sc1 lds
    v_mfma_i32_16x16x64_i8 v[128:131], a[72:75], v[32:35], v[128:131]
    ds_read_b128 v[60:63], v245 offset:37120
    s_add_u32 m0, s7, 77824
    v_mfma_i32_16x16x64_i8 v[124:127], a[8:11], v[36:39], v[124:127]
    buffer_load_dwordx4 v3, s[36:39], m0 offen sc1 lds
    v_mfma_i32_16x16x64_i8 v[132:135], a[72:75], v[36:39], v[132:135]
    ds_read_b128 v[16:19], v244 offset:6144
    s_add_u32 m0, s7, 110592
    v_mfma_i32_16x16x64_i8 v[136:139], a[8:11], v[40:43], v[136:139]
    v_mfma_i32_16x16x64_i8 v[144:147], a[72:75], v[40:43], v[144:147]
    ds_read_b128 v[20:23], v244 offset:6400
    v_mfma_i32_16x16x64_i8 v[140:143], a[8:11], v[44:47], v[140:143]
    buffer_load_dwordx4 v3, s[36:39], m0 offen sc1 lds
    v_mfma_i32_16x16x64_i8 v[148:151], a[72:75], v[44:47], v[148:151]
    ds_read_b128 v[24:27], v244 offset:38912
    s_waitcnt lgkmcnt(3)
    v_mfma_i32_16x16x64_i8 v[152:155], a[8:11], v[48:51], v[152:155]
    v_mfma_i32_16x16x64_i8 v[160:163], a[72:75], v[48:51], v[160:163]
    ds_read_b128 v[28:31], v244 offset:39168
    v_mfma_i32_16x16x64_i8 v[156:159], a[8:11], v[52:55], v[156:159]
    buffer_load_dwordx4 a[24:27], v3, s[16:19], s62 offen offset:2048 sc1
    v_mfma_i32_16x16x64_i8 v[164:167], a[72:75], v[52:55], v[164:167]
    ds_read_b128 v[32:35], v245 offset:6144
    v_mfma_i32_16x16x64_i8 v[168:171], a[8:11], v[56:59], v[168:171]
    v_mfma_i32_16x16x64_i8 v[176:179], a[72:75], v[56:59], v[176:179]
    ds_read_b128 v[36:39], v245 offset:6400
    v_mfma_i32_16x16x64_i8 v[172:175], a[8:11], v[60:63], v[172:175]
    buffer_load_dwordx4 a[88:91], v3, s[16:19], s63 offen offset:2048 sc1
    v_mfma_i32_16x16x64_i8 v[180:183], a[72:75], v[60:63], v[180:183]
    ds_read_b128 v[40:43], v245 offset:38912
    s_waitcnt vmcnt(20) lgkmcnt(3)
    v_mfma_i32_16x16x64_i8 v[120:123], a[12:15], v[16:19], v[120:123]
    ds_read2_b32 v[64:65], v248 offset0:0 offset1:32
    ds_read2_b32 v[68:69], v248 offset0:16 offset1:48
    v_mfma_i32_16x16x64_i8 v[128:131], a[76:79], v[16:19], v[128:131]
    ds_read_b128 v[44:47], v245 offset:39168
    ds_read2_b32 v[72:73], v248 offset0:64 offset1:96
    v_mfma_i32_16x16x64_i8 v[124:127], a[12:15], v[20:23], v[124:127]
    buffer_load_dwordx4 a[28:31], v3, s[16:19], s62 offen offset:3072 sc1
    v_mfma_i32_16x16x64_i8 v[132:135], a[76:79], v[20:23], v[132:135]
    s_waitcnt vmcnt(11)
    v_cmp_ne_u32 vcc, s43, v236
    s_cbranch_vccnz PO2_SLOW
PO2_OK:
    s_barrier
    s_mov_b64 exec, 1
    buffer_store_dword v235, v232, s[16:19], s33 offen sc1
    s_mov_b64 exec, -1
    ds_read_b128 v[48:51], v244 offset:8192
    v_mfma_i32_16x16x64_i8 v[136:139], a[12:15], v[24:27], v[136:139]
    buffer_load_dwordx4 a[92:95], v3, s[16:19], s63 offen offset:3072 sc1
    v_mfma_i32_16x16x64_i8 v[144:147], a[76:79], v[24:27], v[144:147]
    ds_read_b128 v[52:55], v244 offset:8448
    s_add_u32 m0, s4, 16384
    v_mfma_i32_16x16x64_i8 v[140:143], a[12:15], v[28:31], v[140:143]
    buffer_load_dwordx4 v3, s[36:39], m0 offen sc1 lds
    v_mfma_i32_16x16x64_i8 v[148:151], a[76:79], v[28:31], v[148:151]
    ds_read_b128 v[56:59], v244 offset:40960
    s_waitcnt lgkmcnt(4)
    v_mfma_i32_16x16x64_i8 v[152:155], a[12:15], v[32:35], v[152:155]
    s_add_u32 m0, s4, 49152
    ds_read2_b32 v[76:77], v248 offset0:80 offset1:112
    v_mfma_i32_16x16x64_i8 v[160:163], a[76:79], v[32:35], v[160:163]
    ds_read_b128 v[60:63], v244 offset:41216
    ds_read2_b32 v[80:81], v248 offset0:128 offset1:160
    v_mfma_i32_16x16x64_i8 v[156:159], a[12:15], v[36:39], v[156:159]
    buffer_load_dwordx4 v3, s[36:39], m0 offen sc1 lds
    v_mfma_i32_16x16x64_i8 v[164:167], a[76:79], v[36:39], v[164:167]
    ds_read_b128 v[16:19], v245 offset:8192
    s_add_u32 m0, s5, 81920
    v_mfma_i32_16x16x64_i8 v[168:171], a[12:15], v[40:43], v[168:171]
    ds_read2_b32 v[84:85], v248 offset0:144 offset1:176
    ds_read2_b32 v[88:89], v249 offset0:192 offset1:224
    v_mfma_i32_16x16x64_i8 v[176:179], a[76:79], v[40:43], v[176:179]
    ds_read_b128 v[20:23], v245 offset:8448
    v_add_u32 v248, 1024, v248
    v_mfma_i32_16x16x64_i8 v[172:175], a[12:15], v[44:47], v[172:175]
    buffer_load_dwordx4 v3, s[36:39], m0 offen sc1 lds
    v_mfma_i32_16x16x64_i8 v[180:183], a[76:79], v[44:47], v[180:183]
    ds_read_b128 v[24:27], v245 offset:40960
    s_waitcnt vmcnt(14) lgkmcnt(6)
    v_mfma_i32_16x16x64_i8 v[120:123], a[16:19], v[48:51], v[120:123]
    s_add_u32 m0, s5, 114688
    v_add_u32 v249, 1024, v249
    v_mfma_i32_16x16x64_i8 v[128:131], a[80:83], v[48:51], v[128:131]
    ds_read_b128 v[28:31], v245 offset:41216
    v_mfma_i32_16x16x64_i8 v[124:127], a[16:19], v[52:55], v[124:127]
    buffer_load_dwordx4 v3, s[36:39], m0 offen sc1 lds
    v_mfma_i32_16x16x64_i8 v[132:135], a[80:83], v[52:55], v[132:135]
    ds_read_b128 v[32:35], v244 offset:10240
    s_add_u32 s53, s53, 139264
    buffer_load_dword v236, v233, s[16:19], s53 offen sc1
    v_mfma_i32_16x16x64_i8 v[136:139], a[16:19], v[56:59], v[136:139]
    s_xor_b32 s62, s62, 12288
    v_mfma_i32_16x16x64_i8 v[144:147], a[80:83], v[56:59], v[144:147]
    ds_read_b128 v[36:39], v244 offset:10496
    v_mfma_i32_16x16x64_i8 v[140:143], a[16:19], v[60:63], v[140:143]
    buffer_load_dwordx4 a[32:35], v3, s[16:19], s62 offen offset:0 sc1
    v_mfma_i32_16x16x64_i8 v[148:151], a[80:83], v[60:63], v[148:151]
    ds_read_b128 v[40:43], v244 offset:43008
    s_waitcnt lgkmcnt(3)
    v_mfma_i32_16x16x64_i8 v[152:155], a[16:19], v[16:19], v[152:155]
    s_xor_b32 s63, s63, 12288
    v_mfma_i32_16x16x64_i8 v[160:163], a[80:83], v[16:19], v[160:163]
    ds_read_b128 v[44:47], v244 offset:43264
    v_mfma_i32_16x16x64_i8 v[156:159], a[16:19], v[20:23], v[156:159]
    buffer_load_dwordx4 a[96:99], v3, s[16:19], s63 offen offset:0 sc1
    v_mfma_i32_16x16x64_i8 v[164:167], a[80:83], v[20:23], v[164:167]
    ds_read_b128 v[48:51], v245 offset:10240
    v_mfma_i32_16x16x64_i8 v[168:171], a[16:19], v[24:27], v[168:171]
    v_mfma_i32_16x16x64_i8 v[176:179], a[80:83], v[24:27], v[176:179]
    ds_read_b128 v[52:55], v245 offset:10496
    v_mfma_i32_16x16x64_i8 v[172:175], a[16:19], v[28:31], v[172:175]
    buffer_load_dwordx4 a[36:39], v3, s[16:19], s62 offen offset:1024 sc1
    v_mfma_i32_16x16x64_i8 v[180:183], a[80:83], v[28:31], v[180:183]
    ds_read_b128 v[56:59], v245 offset:43008
    s_waitcnt vmcnt(17) lgkmcnt(3)
    v_mfma_i32_16x16x64_i8 v[120:123], a[20:23], v[32:35], v[120:123]
    v_mfma_i32_16x16x64_i8 v[128:131], a[84:87], v[32:35], v[128:131]
    ds_read_b128 v[60:63], v245 offset:43264
    v_mfma_i32_16x16x64_i8 v[124:127], a[20:23], v[36:39], v[124:127]
    buffer_load_dwordx4 a[100:103], v3, s[16:19], s63 offen offset:1024 sc1
    v_mfma_i32_16x16x64_i8 v[132:135], a[84:87], v[36:39], v[132:135]
    s_waitcnt vmcnt(14)
    s_barrier
    ds_read_b128 v[16:19], v244 offset:12288
    v_mfma_i32_16x16x64_i8 v[136:139], a[20:23], v[40:43], v[136:139]
    s_add_u32 m0, s6, 20480
    v_mfma_i32_16x16x64_i8 v[144:147], a[84:87], v[40:43], v[144:147]
    ds_read_b128 v[20:23], v244 offset:12544
    v_mfma_i32_16x16x64_i8 v[140:143], a[20:23], v[44:47], v[140:143]
    buffer_load_dwordx4 v3, s[36:39], m0 offen sc1 lds
    v_mfma_i32_16x16x64_i8 v[148:151], a[84:87], v[44:47], v[148:151]
    ds_read_b128 v[24:27], v244 offset:45056
    s_waitcnt lgkmcnt(3)
    v_mfma_i32_16x16x64_i8 v[152:155], a[20:23], v[48:51], v[152:155]
    s_add_u32 m0, s6, 53248
    v_mfma_i32_16x16x64_i8 v[160:163], a[84:87], v[48:51], v[160:163]
    ds_read_b128 v[28:31], v244 offset:45312
    v_mfma_i32_16x16x64_i8 v[156:159], a[20:23], v[52:55], v[156:159]
    buffer_load_dwordx4 v3, s[36:39], m0 offen sc1 lds
    v_mfma_i32_16x16x64_i8 v[164:167], a[84:87], v[52:55], v[164:167]
    ds_read_b128 v[32:35], v245 offset:12288
    s_add_u32 m0, s7, 86016
    v_mfma_i32_16x16x64_i8 v[168:171], a[20:23], v[56:59], v[168:171]
    v_mfma_i32_16x16x64_i8 v[176:179], a[84:87], v[56:59], v[176:179]
    ds_read_b128 v[36:39], v245 offset:12544
    v_mfma_i32_16x16x64_i8 v[172:175], a[20:23], v[60:63], v[172:175]
    buffer_load_dwordx4 v3, s[36:39], m0 offen sc1 lds
    v_mfma_i32_16x16x64_i8 v[180:183], a[84:87], v[60:63], v[180:183]
    ds_read_b128 v[40:43], v245 offset:45056
    s_waitcnt vmcnt(15) lgkmcnt(3)
    v_mfma_i32_16x16x64_i8 v[120:123], a[24:27], v[16:19], v[120:123]
    s_add_u32 m0, s7, 118784
    v_mfma_i32_16x16x64_i8 v[128:131], a[88:91], v[16:19], v[128:131]
    ds_read_b128 v[44:47], v245 offset:45312
    v_mfma_i32_16x16x64_i8 v[124:127], a[24:27], v[20:23], v[124:127]
    buffer_load_dwordx4 v3, s[36:39], m0 offen sc1 lds
    v_mfma_i32_16x16x64_i8 v[132:135], a[88:91], v[20:23], v[132:135]
    ds_read_b128 v[48:51], v244 offset:14336
    v_mfma_i32_16x16x64_i8 v[136:139], a[24:27], v[24:27], v[136:139]
    v_mfma_i32_16x16x64_i8 v[144:147], a[88:91], v[24:27], v[144:147]
    ds_read_b128 v[52:55], v244 offset:14592
    v_mfma_i32_16x16x64_i8 v[140:143], a[24:27], v[28:31], v[140:143]
    buffer_load_dwordx4 a[40:43], v3, s[16:19], s62 offen offset:2048 sc1
    v_mfma_i32_16x16x64_i8 v[148:151], a[88:91], v[28:31], v[148:151]
    ds_read_b128 v[56:59], v244 offset:47104
    s_waitcnt lgkmcnt(3)
    v_mfma_i32_16x16x64_i8 v[152:155], a[24:27], v[32:35], v[152:155]
    v_mfma_i32_16x16x64_i8 v[160:163], a[88:91], v[32:35], v[160:163]
    ds_read_b128 v[60:63], v244 offset:47360
    v_mfma_i32_16x16x64_i8 v[156:159], a[24:27], v[36:39], v[156:159]
    buffer_load_dwordx4 a[104:107], v3, s[16:19], s63 offen offset:2048 sc1
    v_mfma_i32_16x16x64_i8 v[164:167], a[88:91], v[36:39], v[164:167]
    ds_read_b128 v[16:19], v245 offset:14336
    v_mfma_i32_16x16x64_i8 v[168:171], a[24:27], v[40:43], v[168:171]
    v_mfma_i32_16x16x64_i8 v[176:179], a[88:91], v[40:43], v[176:179]
    ds_read_b128 v[20:23], v245 offset:14592
    v_mfma_i32_16x16x64_i8 v[172:175], a[24:27], v[44:47], v[172:175]
    buffer_load_dwordx4 a[44:47], v3, s[16:19], s62 offen offset:3072 sc1
    v_mfma_i32_16x16x64_i8 v[180:183], a[88:91], v[44:47], v[180:183]
    ds_read_b128 v[24:27], v245 offset:47104
    s_waitcnt vmcnt(16) lgkmcnt(3)
    v_mfma_i32_16x16x64_i8 v[120:123], a[28:31], v[48:51], v[120:123]
    v_mfma_i32_16x16x64_i8 v[128:131], a[92:95], v[48:51], v[128:131]
    ds_read_b128 v[28:31], v245 offset:47360
    v_mfma_i32_16x16x64_i8 v[124:127], a[28:31], v[52:55], v[124:127]
    buffer_load_dwordx4 a[108:111], v3, s[16:19], s63 offen offset:3072 sc1
    v_mfma_i32_16x16x64_i8 v[132:135], a[92:95], v[52:55], v[132:135]
    s_waitcnt vmcnt(12)
    v_cmp_ne_u32 vcc, s43, v236
    s_cbranch_vccnz PO3_SLOW
PO3_OK:
    s_barrier
    ds_read_b128 v[32:35], v244 offset:16384
    v_mfma_i32_16x16x64_i8 v[136:139], a[28:31], v[56:59], v[136:139]
    buffer_load_dwordx2 v[96:97], v251, s[16:19], s32 offen offset:0 sc1
    v_mfma_i32_16x16x64_i8 v[144:147], a[92:95], v[56:59], v[144:147]
    ds_read_b128 v[36:39], v244 offset:16640
    v_mfma_i32_16x16x64_i8 v[140:143], a[28:31], v[60:63], v[140:143]
    buffer_load_dwordx2 v[98:99], v251, s[16:19], s32 offen offset:512 sc1
    v_mfma_i32_16x16x64_i8 v[148:151], a[92:95], v[60:63], v[148:151]
    ds_read_b128 v[40:43], v244 offset:49152
    s_waitcnt lgkmcnt(3)
    v_mfma_i32_16x16x64_i8 v[152:155], a[28:31], v[16:19], v[152:155]
    buffer_load_dwordx2 v[100:101], v251, s[16:19], s32 offen offset:1024 sc1
    v_mfma_i32_16x16x64_i8 v[160:163], a[92:95], v[16:19], v[160:163]
    ds_read_b128 v[44:47], v244 offset:49408
    v_mfma_i32_16x16x64_i8 v[156:159], a[28:31], v[20:23], v[156:159]
    buffer_load_dwordx2 v[102:103], v251, s[16:19], s32 offen offset:1536 sc1
    v_mfma_i32_16x16x64_i8 v[164:167], a[92:95], v[20:23], v[164:167]
    ds_read_b128 v[48:51], v245 offset:16384
    s_add_u32 m0, s4, 24576
    v_mfma_i32_16x16x64_i8 v[168:171], a[28:31], v[24:27], v[168:171]
    buffer_load_dwordx4 v3, s[36:39], m0 offen sc1 lds
    v_mfma_i32_16x16x64_i8 v[176:179], a[92:95], v[24:27], v[176:179]
    ds_read_b128 v[52:55], v245 offset:16640
    s_add_u32 m0, s4, 57344
    v_mfma_i32_16x16x64_i8 v[172:175], a[28:31], v[28:31], v[172:175]
    v_mfma_i32_16x16x64_i8 v[180:183], a[92:95], v[28:31], v[180:183]
    ds_read_b128 v[56:59], v245 offset:49152
    s_waitcnt vmcnt(15) lgkmcnt(3)
    v_mfma_i32_16x16x64_i8 v[120:123], a[32:35], v[32:35], v[120:123]
    buffer_load_dwordx4 v3, s[36:39], m0 offen sc1 lds
    v_mfma_i32_16x16x64_i8 v[128:131], a[96:99], v[32:35], v[128:131]
    ds_read_b128 v[60:63], v245 offset:49408
    s_add_u32 m0, s5, 90112
    v_mfma_i32_16x16x64_i8 v[124:127], a[32:35], v[36:39], v[124:127]
    v_mfma_i32_16x16x64_i8 v[132:135], a[96:99], v[36:39], v[132:135]
    ds_read_b128 v[16:19], v244 offset:18432
    v_mfma_i32_16x16x64_i8 v[136:139], a[32:35], v[40:43], v[136:139]
    buffer_load_dwordx4 v3, s[36:39], m0 offen sc1 lds
    v_mfma_i32_16x16x64_i8 v[144:147], a[96:99], v[40:43], v[144:147]
    ds_read_b128 v[20:23], v244 offset:18688
    s_add_u32 m0, s5, 122880
    v_mfma_i32_16x16x64_i8 v[140:143], a[32:35], v[44:47], v[140:143]
    v_mfma_i32_16x16x64_i8 v[148:151], a[96:99], v[44:47], v[148:151]
    ds_read_b128 v[24:27], v244 offset:51200
    s_waitcnt lgkmcnt(3)
    v_mfma_i32_16x16x64_i8 v[152:155], a[32:35], v[48:51], v[152:155]
    buffer_load_dwordx4 v3, s[36:39], m0 offen sc1 lds
    v_mfma_i32_16x16x64_i8 v[160:163], a[96:99], v[48:51], v[160:163]
    ds_read_b128 v[28:31], v244 offset:51456
    s_add_u32 s53, s53, 139264
    buffer_load_dword v236, v234, s[16:19], s53 offen sc1
    v_mfma_i32_16x16x64_i8 v[156:159], a[32:35], v[52:55], v[156:159]
    s_xor_b32 s62, s62, 4096
    v_mfma_i32_16x16x64_i8 v[164:167], a[96:99], v[52:55], v[164:167]
    ds_read_b128 v[32:35], v245 offset:18432
    v_mfma_i32_16x16x64_i8 v[168:171], a[32:35], v[56:59], v[168:171]
ISL1:
    s_cbranch_vccnz ISL2
    buffer_load_dwordx4 a[48:51], v3, s[16:19], s62 offen offset:0 sc1
    v_mfma_i32_16x16x64_i8 v[176:179], a[96:99], v[56:59], v[176:179]
    ds_read_b128 v[36:39], v245 offset:18688
    s_xor_b32 s63, s63, 4096
    v_mfma_i32_16x16x64_i8 v[172:175], a[32:35], v[60:63], v[172:175]
    v_mfma_i32_16x16x64_i8 v[180:183], a[96:99], v[60:63], v[180:183]
    ds_read_b128 v[40:43], v245 offset:51200
    s_waitcnt vmcnt(18) lgkmcnt(3)
    v_mfma_i32_16x16x64_i8 v[120:123], a[36:39], v[16:19], v[120:123]
    buffer_load_dwordx4 a[112:115], v3, s[16:19], s63 offen offset:0 sc1
    v_mfma_i32_16x16x64_i8 v[128:131], a[100:103], v[16:19], v[128:131]
    ds_read_b128 v[44:47], v245 offset:51456
    v_mfma_i32_16x16x64_i8 v[124:127], a[36:39], v[20:23], v[124:127]
    v_mfma_i32_16x16x64_i8 v[132:135], a[100:103], v[20:23], v[132:135]
    s_waitcnt vmcnt(15)
    s_barrier
    ds_read_b128 v[48:51], v244 offset:20480
    v_mfma_i32_16x16x64_i8 v[136:139], a[36:39], v[24:27], v[136:139]
    buffer_load_dwordx4 a[52:55], v3, s[16:19], s62 offen offset:1024 sc1
    v_mfma_i32_16x16x64_i8 v[144:147], a[100:103], v[24:27], v[144:147]
    ds_read_b128 v[52:55], v244 offset:20736
    v_mfma_i32_16x16x64_i8 v[140:143], a[36:39], v[28:31], v[140:143]
    buffer_load_dwordx4 a[116:119], v3, s[16:19], s63 offen offset:1024 sc1
    v_mfma_i32_16x16x64_i8 v[148:151], a[100:103], v[28:31], v[148:151]
    ds_read_b128 v[56:59], v244 offset:53248
    s_waitcnt lgkmcnt(3)
    v_mfma_i32_16x16x64_i8 v[152:155], a[36:39], v[32:35], v[152:155]
    s_add_u32 m0, s6, 28672
    v_mfma_i32_16x16x64_i8 v[160:163], a[100:103], v[32:35], v[160:163]
    ds_read_b128 v[60:63], v244 offset:53504
    v_mfma_i32_16x16x64_i8 v[156:159], a[36:39], v[36:39], v[156:159]
    buffer_load_dwordx4 v3, s[36:39], m0 offen sc1 lds
    v_mfma_i32_16x16x64_i8 v[164:167], a[100:103], v[36:39], v[164:167]
    ds_read_b128 v[16:19], v245 offset:20480
    s_add_u32 m0, s6, 61440
    v_mfma_i32_16x16x64_i8 v[168:171], a[36:39], v[40:43], v[168:171]
    v_mfma_i32_16x16x64_i8 v[176:179], a[100:103], v[40:43], v[176:179]
    ds_read_b128 v[20:23], v245 offset:20736
    v_mfma_i32_16x16x64_i8 v[172:175], a[36:39], v[44:47], v[172:175]
    buffer_load_dwordx4 v3, s[36:39], m0 offen sc1 lds
    v_mfma_i32_16x16x64_i8 v[180:183], a[100:103], v[44:47], v[180:183]
    ds_read_b128 v[24:27], v245 offset:53248
    s_waitcnt vmcnt(17) lgkmcnt(3)
    v_mfma_i32_16x16x64_i8 v[120:123], a[40:43], v[48:51], v[120:123]
    s_waitcnt vmcnt(11)
    v_pk_add_i16 v96, v96, v100
    v_mfma_i32_16x16x64_i8 v[128:131], a[104:107], v[48:51], v[128:131]
    ds_read_b128 v[28:31], v245 offset:53504
    v_pk_add_i16 v97, v97, v101
    v_mfma_i32_16x16x64_i8 v[124:127], a[40:43], v[52:55], v[124:127]
    buffer_load_dwordx4 a[56:59], v3, s[16:19], s62 offen offset:2048 sc1
    v_mfma_i32_16x16x64_i8 v[132:135], a[104:107], v[52:55], v[132:135]
    ds_read_b128 v[32:35], v244 offset:22528
    v_pk_add_i16 v98, v98, v102
    v_mfma_i32_16x16x64_i8 v[136:139], a[40:43], v[56:59], v[136:139]
    buffer_load_dwordx4 a[120:123], v3, s[16:19], s63 offen offset:2048 sc1
    v_mfma_i32_16x16x64_i8 v[144:147], a[104:107], v[56:59], v[144:147]
    ds_read_b128 v[36:39], v244 offset:22784
    v_pk_add_i16 v99, v99, v103
    v_mfma_i32_16x16x64_i8 v[140:143], a[40:43], v[60:63], v[140:143]
    buffer_load_dwordx4 a[60:63], v3, s[16:19], s62 offen offset:3072 sc1
    v_mfma_i32_16x16x64_i8 v[148:151], a[104:107], v[60:63], v[148:151]
    ds_read_b128 v[40:43], v244 offset:55296
    s_waitcnt lgkmcnt(3)
    v_mfma_i32_16x16x64_i8 v[152:155], a[40:43], v[16:19], v[152:155]
    buffer_load_dwordx4 a[124:127], v3, s[16:19], s63 offen offset:3072 sc1
    v_mfma_i32_16x16x64_i8 v[160:163], a[104:107], v[16:19], v[160:163]
    ds_read_b128 v[44:47], v244 offset:55552
    s_add_u32 m0, s7, 94208
    v_mfma_i32_16x16x64_i8 v[156:159], a[40:43], v[20:23], v[156:159]
    v_pk_add_i16 v96, v96, v98
    v_pk_add_i16 v97, v97, v99
    v_mfma_i32_16x16x64_i8 v[164:167], a[104:107], v[20:23], v[164:167]
    ds_read_b128 v[48:51], v245 offset:22528
    v_bfe_i32 v92, v96, 0, 16
    v_mfma_i32_16x16x64_i8 v[168:171], a[40:43], v[24:27], v[168:171]
    buffer_load_dwordx4 v3, s[36:39], m0 offen sc1 lds
    v_mfma_i32_16x16x64_i8 v[176:179], a[104:107], v[24:27], v[176:179]
    ds_read_b128 v[52:55], v245 offset:22784
    s_add_u32 m0, s7, 126976
    v_mfma_i32_16x16x64_i8 v[172:175], a[40:43], v[28:31], v[172:175]
    v_ashrrev_i32 v93, 16, v96
    v_bfe_i32 v94, v97, 0, 16
    v_mfma_i32_16x16x64_i8 v[180:183], a[104:107], v[28:31], v[180:183]
    ds_read_b128 v[56:59], v245 offset:55296
    s_waitcnt lgkmcnt(3)
    v_mfma_i32_16x16x64_i8 v[120:123], a[44:47], v[32:35], v[120:123]
    buffer_load_dwordx4 v3, s[36:39], m0 offen sc1 lds
    v_mfma_i32_16x16x64_i8 v[128:131], a[108:111], v[32:35], v[128:131]
    ds_read_b128 v[60:63], v245 offset:55552
    v_ashrrev_i32 v95, 16, v97
    v_mfma_i32_16x16x64_i8 v[124:127], a[44:47], v[36:39], v[124:127]
    v_permlane32_swap_b32 v92, v93
    s_nop 0
    v_mfma_i32_16x16x64_i8 v[132:135], a[108:111], v[36:39], v[132:135]
    s_waitcnt vmcnt(12)
    v_cmp_ne_u32 vcc, s43, v236
    s_cbranch_vccnz PO4_SLOW
PO4_OK:
    s_barrier
    ds_read_b128 v[16:19], v244 offset:24576
    v_mfma_i32_16x16x64_i8 v[136:139], a[44:47], v[40:43], v[136:139]
    s_add_u32 s44, s61, 131072
    s_add_u32 m0, s61, 0
    v_mfma_i32_16x16x64_i8 v[144:147], a[108:111], v[40:43], v[144:147]
    ds_read_b128 v[20:23], v244 offset:24832
    v_permlane32_swap_b32 v94, v95
    v_mfma_i32_16x16x64_i8 v[140:143], a[44:47], v[44:47], v[140:143]
    buffer_load_dwordx4 v3, s[36:39], s44 offen offset:0 sc1 lds
    v_mfma_i32_16x16x64_i8 v[148:151], a[108:111], v[44:47], v[148:151]
    ds_read_b128 v[24:27], v244 offset:57344
    s_waitcnt lgkmcnt(3)
    v_mfma_i32_16x16x64_i8 v[152:155], a[44:47], v[48:51], v[152:155]
    buffer_load_dwordx4 v3, s[36:39], s44 offen offset:1024 sc1 lds
    v_mfma_i32_16x16x64_i8 v[160:163], a[108:111], v[48:51], v[160:163]
    ds_read_b128 v[28:31], v244 offset:57600
    v_add_u32 v92, v92, v93
    v_mfma_i32_16x16x64_i8 v[156:159], a[44:47], v[52:55], v[156:159]
    v_add_u32 v94, v94, v95
    s_nop 1
    v_mfma_i32_16x16x64_i8 v[164:167], a[108:111], v[52:55], v[164:167]
    ds_read_b128 v[32:35], v245 offset:24576
    v_permlane16_swap_b32 v92, v94
    v_mfma_i32_16x16x64_i8 v[168:171], a[44:47], v[56:59], v[168:171]
    buffer_load_dwordx4 v3, s[36:39], s44 offen offset:2048 sc1 lds
    v_mfma_i32_16x16x64_i8 v[176:179], a[108:111], v[56:59], v[176:179]
    ds_read_b128 v[36:39], v245 offset:24832
    v_add_u32 v92, v92, v94
    v_mfma_i32_16x16x64_i8 v[172:175], a[44:47], v[60:63], v[172:175]
    v_cvt_f32_i32 v92, v92
    v_cvt_pk_bf16_f32 v92, v92, v92
    v_mfma_i32_16x16x64_i8 v[180:183], a[108:111], v[60:63], v[180:183]
    ds_read_b128 v[40:43], v245 offset:57344
    s_waitcnt vmcnt(13) lgkmcnt(3)
    v_mfma_i32_16x16x64_i8 v[120:123], a[48:51], v[16:19], v[120:123]
    buffer_load_dwordx4 v3, s[36:39], s44 offen offset:3072 sc1 lds
    v_mfma_i32_16x16x64_i8 v[128:131], a[112:115], v[16:19], v[128:131]
    ds_read_b128 v[44:47], v245 offset:57600
    v_lshlrev_b32 v92, 16, v92
    v_mfma_i32_16x16x64_i8 v[124:127], a[48:51], v[20:23], v[124:127]
    v_mul_f32 v92, v92, v252
    v_cvt_pk_bf16_f32 v92, v92, v92
    v_mfma_i32_16x16x64_i8 v[132:135], a[112:115], v[20:23], v[132:135]
    ds_read_b128 v[48:51], v244 offset:26624
    v_lshlrev_b32 v92, 16, v92
    v_mfma_i32_16x16x64_i8 v[136:139], a[48:51], v[24:27], v[136:139]
    buffer_load_dwordx2 v[8:9], v251, s[16:19], s35 offen offset:0 sc1
    v_mfma_i32_16x16x64_i8 v[144:147], a[112:115], v[24:27], v[144:147]
    ds_read_b128 v[52:55], v244 offset:26880
    v_fma_f32 v239, -v92, v238, v239
    v_mfma_i32_16x16x64_i8 v[140:143], a[48:51], v[28:31], v[140:143]
    buffer_load_dwordx2 v[10:11], v251, s[16:19], s35 offen offset:512 sc1
    v_mfma_i32_16x16x64_i8 v[148:151], a[112:115], v[28:31], v[148:151]
    ds_read_b128 v[56:59], v244 offset:59392
    s_waitcnt lgkmcnt(3)
    v_mfma_i32_16x16x64_i8 v[152:155], a[48:51], v[32:35], v[152:155]
    buffer_load_dwordx2 v[12:13], v251, s[16:19], s35 offen offset:1024 sc1
    v_mfma_i32_16x16x64_i8 v[160:163], a[112:115], v[32:35], v[160:163]
    ds_read_b128 v[60:63], v244 offset:59648
    v_fma_f32 v239, v238, s34, v239
    v_mfma_i32_16x16x64_i8 v[156:159], a[48:51], v[36:39], v[156:159]
    buffer_load_dwordx2 v[14:15], v251, s[16:19], s35 offen offset:1536 sc1
    v_mfma_i32_16x16x64_i8 v[164:167], a[112:115], v[36:39], v[164:167]
    ds_read_b128 v[16:19], v245 offset:26624
    s_add_u32 s44, s61, 147456
    v_mfma_i32_16x16x64_i8 v[168:171], a[48:51], v[40:43], v[168:171]
    s_add_u32 m0, s61, 32768
    ds_write_b32 v250, v239 offset:1024
    v_mfma_i32_16x16x64_i8 v[176:179], a[112:115], v[40:43], v[176:179]
    ds_read_b128 v[20:23], v245 offset:26880
    v_mfma_i32_16x16x64_i8 v[172:175], a[48:51], v[44:47], v[172:175]
    buffer_load_dwordx4 v3, s[36:39], s44 offen offset:0 sc1 lds
    v_mfma_i32_16x16x64_i8 v[180:183], a[112:115], v[44:47], v[180:183]
    ds_read_b128 v[24:27], v245 offset:59392
    s_waitcnt vmcnt(17) lgkmcnt(4)
    v_mfma_i32_16x16x64_i8 v[120:123], a[52:55], v[48:51], v[120:123]
    v_mfma_i32_16x16x64_i8 v[128:131], a[116:119], v[48:51], v[128:131]
    ds_read_b128 v[28:31], v245 offset:59648
    v_mfma_i32_16x16x64_i8 v[124:127], a[52:55], v[52:55], v[124:127]
    buffer_load_dwordx4 v3, s[36:39], s44 offen offset:1024 sc1 lds
    v_mfma_i32_16x16x64_i8 v[132:135], a[116:119], v[52:55], v[132:135]
    s_waitcnt vmcnt(16)
    s_barrier
    ds_read_b128 v[32:35], v244 offset:28672
    v_mfma_i32_16x16x64_i8 v[136:139], a[52:55], v[56:59], v[136:139]
    v_mfma_i32_16x16x64_i8 v[144:147], a[116:119], v[56:59], v[144:147]
    ds_read_b128 v[36:39], v244 offset:28928
    v_mfma_i32_16x16x64_i8 v[140:143], a[52:55], v[60:63], v[140:143]
    buffer_load_dwordx4 v3, s[36:39], s44 offen offset:2048 sc1 lds
    v_mfma_i32_16x16x64_i8 v[148:151], a[116:119], v[60:63], v[148:151]
    ds_read_b128 v[40:43], v244 offset:61440
    s_waitcnt lgkmcnt(3)
    v_mfma_i32_16x16x64_i8 v[152:155], a[52:55], v[16:19], v[152:155]
    v_mfma_i32_16x16x64_i8 v[160:163], a[116:119], v[16:19], v[160:163]
    ds_read_b128 v[44:47], v244 offset:61696
    v_mfma_i32_16x16x64_i8 v[156:159], a[52:55], v[20:23], v[156:159]
    buffer_load_dwordx4 v3, s[36:39], s44 offen offset:3072 sc1 lds
    v_mfma_i32_16x16x64_i8 v[164:167], a[116:119], v[20:23], v[164:167]
    ds_read_b128 v[48:51], v244 offset:30720
    s_add_u32 s44, s61, 163840
    v_mfma_i32_16x16x64_i8 v[168:171], a[52:55], v[24:27], v[168:171]
    s_add_u32 m0, s61, 65536
    v_mfma_i32_16x16x64_i8 v[176:179], a[116:119], v[24:27], v[176:179]
    ds_read_b128 v[52:55], v244 offset:30976
    v_mfma_i32_16x16x64_i8 v[172:175], a[52:55], v[28:31], v[172:175]
    buffer_load_dwordx4 v3, s[36:39], s44 offen offset:0 sc1 lds
    v_mfma_i32_16x16x64_i8 v[180:183], a[116:119], v[28:31], v[180:183]
    ds_read_b128 v[56:59], v244 offset:63488
    s_waitcnt vmcnt(17) lgkmcnt(3)
    v_mfma_i32_16x16x64_i8 v[120:123], a[56:59], v[32:35], v[120:123]
    v_mfma_i32_16x16x64_i8 v[128:131], a[120:123], v[32:35], v[128:131]
    ds_read_b128 v[60:63], v244 offset:63744
    v_mfma_i32_16x16x64_i8 v[124:127], a[56:59], v[36:39], v[124:127]
    buffer_load_dwordx4 v3, s[36:39], s44 offen offset:1024 sc1 lds
    v_mfma_i32_16x16x64_i8 v[132:135], a[120:123], v[36:39], v[132:135]
    s_waitcnt vmcnt(14)
    s_barrier
    ds_read_b128 v[16:19], v245 offset:28672
    v_mfma_i32_16x16x64_i8 v[136:139], a[56:59], v[40:43], v[136:139]
    buffer_load_dwordx4 v3, s[36:39], s44 offen offset:2048 sc1 lds
    v_mfma_i32_16x16x64_i8 v[144:147], a[120:123], v[40:43], v[144:147]
    ds_read_b128 v[20:23], v245 offset:28928
    ds_read2_b32 v[66:67], v248 offset0:0 offset1:32
    v_mfma_i32_16x16x64_i8 v[140:143], a[56:59], v[44:47], v[140:143]
    buffer_load_dwordx4 v3, s[36:39], s44 offen offset:3072 sc1 lds
    v_mfma_i32_16x16x64_i8 v[148:151], a[120:123], v[44:47], v[148:151]
    ds_read_b128 v[24:27], v245 offset:30720
    s_waitcnt lgkmcnt(4)
    v_mfma_i32_16x16x64_i8 v[120:123], a[60:63], v[48:51], v[120:123]
    s_add_u32 s44, s61, 180224
    s_add_u32 m0, s61, 98304
    v_mfma_i32_16x16x64_i8 v[128:131], a[124:127], v[48:51], v[128:131]
    ds_read_b128 v[28:31], v245 offset:30976
    ds_read2_b32 v[70:71], v248 offset0:16 offset1:48
    v_mfma_i32_16x16x64_i8 v[124:127], a[60:63], v[52:55], v[124:127]
    buffer_load_dwordx4 v3, s[36:39], s44 offen offset:0 sc1 lds
    v_mfma_i32_16x16x64_i8 v[132:135], a[124:127], v[52:55], v[132:135]
    ds_read_b128 v[32:35], v245 offset:61440
    ds_read2_b32 v[74:75], v248 offset0:64 offset1:96
    v_mfma_i32_16x16x64_i8 v[136:139], a[60:63], v[56:59], v[136:139]
    ds_read2_b32 v[78:79], v248 offset0:80 offset1:112
    v_mfma_i32_16x16x64_i8 v[144:147], a[124:127], v[56:59], v[144:147]
    ds_read_b128 v[36:39], v245 offset:61696
    v_mfma_i32_16x16x64_i8 v[140:143], a[60:63], v[60:63], v[140:143]
    buffer_load_dwordx4 v3, s[36:39], s44 offen offset:1024 sc1 lds
    v_mfma_i32_16x16x64_i8 v[148:151], a[124:127], v[60:63], v[148:151]
    ds_read_b128 v[40:43], v245 offset:63488
    s_waitcnt lgkmcnt(6)
    v_mfma_i32_16x16x64_i8 v[152:155], a[56:59], v[16:19], v[152:155]
    v_fma_f32 v110, v120, v64, v66
    v_fma_f32 v111, v124, v65, v67
    v_mfma_i32_16x16x64_i8 v[160:163], a[120:123], v[16:19], v[160:163]
    ds_read_b128 v[44:47], v245 offset:63744
    v_cvt_pk_bf16_f32 v92, v110, v111
    v_mfma_i32_16x16x64_i8 v[156:159], a[56:59], v[20:23], v[156:159]
    buffer_load_dwordx4 v3, s[36:39], s44 offen offset:2048 sc1 lds
    v_mfma_i32_16x16x64_i8 v[164:167], a[120:123], v[20:23], v[164:167]
    s_waitcnt vmcnt(15)
    s_barrier
    ds_read_b128 v[48:51], v244 offset:0
    v_mfma_i32_16x16x64_i8 v[152:155], a[60:63], v[24:27], v[152:155]
    buffer_load_dwordx4 v3, s[36:39], s44 offen offset:3072 sc1 lds
    v_mfma_i32_16x16x64_i8 v[160:163], a[124:127], v[24:27], v[160:163]
    ds_read_b128 v[52:55], v244 offset:256
    s_add_u32 s44, s61, 196608
    v_mfma_i32_16x16x64_i8 v[156:159], a[60:63], v[28:31], v[156:159]
    s_add_u32 m0, s61, 16384
    s_waitcnt lgkmcnt(8)
    v_fma_f32 v110, v136, v68, v70
    v_mfma_i32_16x16x64_i8 v[164:167], a[124:127], v[28:31], v[164:167]
    ds_read_b128 v[56:59], v244 offset:2048
    s_waitcnt lgkmcnt(3)
    v_mfma_i32_16x16x64_i8 v[168:171], a[56:59], v[32:35], v[168:171]
    v_fma_f32 v111, v140, v69, v71
    v_cvt_pk_bf16_f32 v93, v110, v111
    v_mfma_i32_16x16x64_i8 v[176:179], a[120:123], v[32:35], v[176:179]
    ds_read_b128 v[60:63], v244 offset:2304
    v_fma_f32 v110, v121, v64, v66
    v_mfma_i32_16x16x64_i8 v[172:175], a[56:59], v[36:39], v[172:175]
    buffer_store_dwordx2 v[92:93], v246, s[28:31], s68 offen offset:0 sc1 nt
    v_fma_f32 v111, v125, v65, v67
    v_mfma_i32_16x16x64_i8 v[180:183], a[120:123], v[36:39], v[180:183]
    ds_read_b128 v[16:19], v244 offset:4096
    v_cvt_pk_bf16_f32 v94, v110, v111
    v_mfma_i32_16x16x64_i8 v[168:171], a[60:63], v[40:43], v[168:171]
    buffer_load_dwordx4 v3, s[36:39], s44 offen offset:0 sc1 lds
    v_mfma_i32_16x16x64_i8 v[176:179], a[124:127], v[40:43], v[176:179]
    ds_read_b128 v[20:23], v244 offset:4352
    v_fma_f32 v110, v137, v68, v70
    v_mfma_i32_16x16x64_i8 v[172:175], a[60:63], v[44:47], v[172:175]
    v_fma_f32 v111, v141, v69, v71
    v_cvt_pk_bf16_f32 v95, v110, v111
    v_mfma_i32_16x16x64_i8 v[180:183], a[124:127], v[44:47], v[180:183]
    ds_read_b128 v[24:27], v244 offset:6144
    s_waitcnt lgkmcnt(3)
    v_mfma_i32_16x16x64_i8 v[184:187], a[0:3], v[48:51], v[112:115]
    v_fma_f32 v110, v122, v64, v66
    v_fma_f32 v111, v126, v65, v67
    v_mfma_i32_16x16x64_i8 v[192:195], a[64:67], v[48:51], v[112:115]
    ds_read_b128 v[28:31], v244 offset:6400
    v_cvt_pk_bf16_f32 v96, v110, v111
    v_mfma_i32_16x16x64_i8 v[188:191], a[0:3], v[52:55], v[112:115]
    buffer_store_dwordx2 v[94:95], v246, s[28:31], s69 offen offset:0 sc1 nt
    v_fma_f32 v110, v138, v68, v70
    v_mfma_i32_16x16x64_i8 v[196:199], a[64:67], v[52:55], v[112:115]
    ds_read_b128 v[32:35], v244 offset:8192
    v_fma_f32 v111, v142, v69, v71
    v_mfma_i32_16x16x64_i8 v[184:187], a[4:7], v[56:59], v[184:187]
    buffer_load_dwordx4 v3, s[36:39], s44 offen offset:1024 sc1 lds
    v_mfma_i32_16x16x64_i8 v[192:195], a[68:71], v[56:59], v[192:195]
    ds_read_b128 v[36:39], v244 offset:8448
    v_cvt_pk_bf16_f32 v97, v110, v111
    v_mfma_i32_16x16x64_i8 v[188:191], a[4:7], v[60:63], v[188:191]
    v_fma_f32 v110, v123, v64, v66
    v_fma_f32 v111, v127, v65, v67
    v_mfma_i32_16x16x64_i8 v[196:199], a[68:71], v[60:63], v[196:199]
    ds_read_b128 v[40:43], v244 offset:10240
    s_waitcnt lgkmcnt(3)
    v_mfma_i32_16x16x64_i8 v[184:187], a[8:11], v[16:19], v[184:187]
    v_cvt_pk_bf16_f32 v98, v110, v111
    v_fma_f32 v110, v139, v68, v70
    v_mfma_i32_16x16x64_i8 v[192:195], a[72:75], v[16:19], v[192:195]
    ds_read_b128 v[44:47], v244 offset:10496
    v_fma_f32 v111, v143, v69, v71
    v_mfma_i32_16x16x64_i8 v[188:191], a[8:11], v[20:23], v[188:191]
    buffer_load_dwordx4 v3, s[36:39], s44 offen offset:2048 sc1 lds
    v_mfma_i32_16x16x64_i8 v[196:199], a[72:75], v[20:23], v[196:199]
    ds_read_b128 v[48:51], v244 offset:12288
    v_cvt_pk_bf16_f32 v99, v110, v111
    v_mfma_i32_16x16x64_i8 v[184:187], a[12:15], v[24:27], v[184:187]
    v_mfma_i32_16x16x64_i8 v[192:195], a[76:79], v[24:27], v[192:195]
    ds_read_b128 v[52:55], v244 offset:12544
    v_mfma_i32_16x16x64_i8 v[188:191], a[12:15], v[28:31], v[188:191]
    buffer_store_dwordx2 v[96:97], v246, s[28:31], s70 offen offset:0 sc1 nt
    v_fma_f32 v110, v128, v64, v66
    v_mfma_i32_16x16x64_i8 v[196:199], a[76:79], v[28:31], v[196:199]
    ds_read_b128 v[56:59], v244 offset:14336
    s_waitcnt lgkmcnt(3)
    v_mfma_i32_16x16x64_i8 v[184:187], a[16:19], v[32:35], v[184:187]
    buffer_load_dwordx4 v3, s[36:39], s44 offen offset:3072 sc1 lds
    v_mfma_i32_16x16x64_i8 v[192:195], a[80:83], v[32:35], v[192:195]
    ds_read_b128 v[60:63], v244 offset:14592
    s_add_u32 s44, s61, 212992
    v_mfma_i32_16x16x64_i8 v[188:191], a[16:19], v[36:39], v[188:191]
    s_add_u32 m0, s61, 49152
    v_fma_f32 v111, v132, v65, v67
    v_mfma_i32_16x16x64_i8 v[196:199], a[80:83], v[36:39], v[196:199]
    s_waitcnt vmcnt(15)
    s_barrier
    ds_read_b128 v[16:19], v244 offset:32768
    v_mfma_i32_16x16x64_i8 v[184:187], a[20:23], v[40:43], v[184:187]
    v_cvt_pk_bf16_f32 v100, v110, v111
    v_fma_f32 v110, v144, v68, v70
    v_mfma_i32_16x16x64_i8 v[192:195], a[84:87], v[40:43], v[192:195]
    ds_read_b128 v[20:23], v244 offset:33024
    v_fma_f32 v111, v148, v69, v71
    v_mfma_i32_16x16x64_i8 v[188:191], a[20:23], v[44:47], v[188:191]
    buffer_load_dwordx4 v3, s[36:39], s44 offen offset:0 sc1 lds
    v_mfma_i32_16x16x64_i8 v[196:199], a[84:87], v[44:47], v[196:199]
    ds_read_b128 v[24:27], v244 offset:34816
    s_waitcnt lgkmcnt(3)
    v_mfma_i32_16x16x64_i8 v[184:187], a[24:27], v[48:51], v[184:187]
    buffer_store_dwordx2 v[98:99], v246, s[28:31], s71 offen offset:0 sc1 nt
    v_cvt_pk_bf16_f32 v101, v110, v111
    v_mfma_i32_16x16x64_i8 v[192:195], a[88:91], v[48:51], v[192:195]
    ds_read_b128 v[28:31], v244 offset:35072
    v_fma_f32 v110, v129, v64, v66
    v_mfma_i32_16x16x64_i8 v[188:191], a[24:27], v[52:55], v[188:191]
    v_fma_f32 v111, v133, v65, v67
    v_cvt_pk_bf16_f32 v102, v110, v111
    v_mfma_i32_16x16x64_i8 v[196:199], a[88:91], v[52:55], v[196:199]
    ds_read_b128 v[32:35], v244 offset:36864
    v_fma_f32 v110, v145, v68, v70
    v_mfma_i32_16x16x64_i8 v[184:187], a[28:31], v[56:59], v[184:187]
    buffer_load_dwordx4 v3, s[36:39], s44 offen offset:1024 sc1 lds
    v_mfma_i32_16x16x64_i8 v[192:195], a[92:95], v[56:59], v[192:195]
    ds_read_b128 v[36:39], v244 offset:37120
    v_fma_f32 v111, v149, v69, v71
    v_mfma_i32_16x16x64_i8 v[188:191], a[28:31], v[60:63], v[188:191]
    v_cvt_pk_bf16_f32 v103, v110, v111
    v_mfma_i32_16x16x64_i8 v[196:199], a[92:95], v[60:63], v[196:199]
    ds_read_b128 v[40:43], v244 offset:38912
    s_waitcnt lgkmcnt(3)
    v_mfma_i32_16x16x64_i8 v[184:187], a[32:35], v[16:19], v[184:187]
    v_mfma_i32_16x16x64_i8 v[192:195], a[96:99], v[16:19], v[192:195]
    ds_read_b128 v[44:47], v244 offset:39168
    v_mfma_i32_16x16x64_i8 v[188:191], a[32:35], v[20:23], v[188:191]
    buffer_load_dwordx4 v3, s[36:39], s44 offen offset:2048 sc1 lds
    v_mfma_i32_16x16x64_i8 v[196:199], a[96:99], v[20:23], v[196:199]
    ds_read_b128 v[48:51], v244 offset:40960
    v_mfma_i32_16x16x64_i8 v[184:187], a[36:39], v[24:27], v[184:187]
    buffer_store_dwordx2 v[100:101], v246, s[28:31], s72 offen offset:0 sc1 nt
    v_fma_f32 v110, v130, v64, v66
    v_mfma_i32_16x16x64_i8 v[192:195], a[100:103], v[24:27], v[192:195]
    ds_read_b128 v[52:55], v244 offset:41216
    v_fma_f32 v111, v134, v65, v67
    v_mfma_i32_16x16x64_i8 v[188:191], a[36:39], v[28:31], v[188:191]
    v_cvt_pk_bf16_f32 v104, v110, v111
    v_fma_f32 v110, v146, v68, v70
    v_mfma_i32_16x16x64_i8 v[196:199], a[100:103], v[28:31], v[196:199]
    ds_read_b128 v[56:59], v244 offset:43008
    s_waitcnt lgkmcnt(3)
    v_mfma_i32_16x16x64_i8 v[184:187], a[40:43], v[32:35], v[184:187]
    buffer_load_dwordx4 v3, s[36:39], s44 offen offset:3072 sc1 lds
    v_mfma_i32_16x16x64_i8 v[192:195], a[104:107], v[32:35], v[192:195]
    ds_read_b128 v[60:63], v244 offset:43264
    v_fma_f32 v111, v150, v69, v71
    v_mfma_i32_16x16x64_i8 v[188:191], a[40:43], v[36:39], v[188:191]
    v_cvt_pk_bf16_f32 v105, v110, v111
    v_mfma_i32_16x16x64_i8 v[196:199], a[104:107], v[36:39], v[196:199]
    ds_read_b128 v[16:19], v244 offset:45056
    v_mfma_i32_16x16x64_i8 v[184:187], a[44:47], v[40:43], v[184:187]
    v_mfma_i32_16x16x64_i8 v[192:195], a[108:111], v[40:43], v[192:195]
    ds_read_b128 v[20:23], v244 offset:45312
    v_mfma_i32_16x16x64_i8 v[188:191], a[44:47], v[44:47], v[188:191]
    buffer_store_dwordx2 v[102:103], v246, s[28:31], s73 offen offset:0 sc1 nt
    v_fma_f32 v110, v131, v64, v66
    v_mfma_i32_16x16x64_i8 v[196:199], a[108:111], v[44:47], v[196:199]
    ds_read_b128 v[24:27], v244 offset:47104
    s_waitcnt lgkmcnt(3)
    v_mfma_i32_16x16x64_i8 v[184:187], a[48:51], v[48:51], v[184:187]
    v_fma_f32 v111, v135, v65, v67
    v_cvt_pk_bf16_f32 v106, v110, v111
    v_mfma_i32_16x16x64_i8 v[192:195], a[112:115], v[48:51], v[192:195]
    ds_read_b128 v[28:31], v244 offset:47360
    v_fma_f32 v110, v147, v68, v70
    v_mfma_i32_16x16x64_i8 v[188:191], a[48:51], v[52:55], v[188:191]
    v_fma_f32 v111, v151, v69, v71
    v_cvt_pk_bf16_f32 v107, v110, v111
    v_mfma_i32_16x16x64_i8 v[196:199], a[112:115], v[52:55], v[196:199]
    s_waitcnt vmcnt(18)
    s_barrier
    ds_read_b128 v[32:35], v245 offset:0
    v_mfma_i32_16x16x64_i8 v[184:187], a[52:55], v[56:59], v[184:187]
    v_mfma_i32_16x16x64_i8 v[192:195], a[116:119], v[56:59], v[192:195]
    ds_read_b128 v[36:39], v245 offset:256
    v_mfma_i32_16x16x64_i8 v[188:191], a[52:55], v[60:63], v[188:191]
    v_mfma_i32_16x16x64_i8 v[196:199], a[116:119], v[60:63], v[196:199]
    ds_read_b128 v[40:43], v245 offset:2048
    s_waitcnt lgkmcnt(3)
    v_mfma_i32_16x16x64_i8 v[184:187], a[56:59], v[16:19], v[184:187]
    buffer_store_dwordx2 v[104:105], v246, s[28:31], s74 offen offset:0 sc1 nt
    v_fma_f32 v110, v152, v72, v74
    v_mfma_i32_16x16x64_i8 v[192:195], a[120:123], v[16:19], v[192:195]
    ds_read_b128 v[44:47], v245 offset:2304
    v_fma_f32 v111, v156, v73, v75
    v_mfma_i32_16x16x64_i8 v[188:191], a[56:59], v[20:23], v[188:191]
    v_cvt_pk_bf16_f32 v92, v110, v111
    v_fma_f32 v110, v168, v76, v78
    v_mfma_i32_16x16x64_i8 v[196:199], a[120:123], v[20:23], v[196:199]
    ds_read_b128 v[48:51], v245 offset:4096
    v_fma_f32 v111, v172, v77, v79
    v_mfma_i32_16x16x64_i8 v[184:187], a[60:63], v[24:27], v[184:187]
    v_cvt_pk_bf16_f32 v93, v110, v111
    v_mfma_i32_16x16x64_i8 v[192:195], a[124:127], v[24:27], v[192:195]
    ds_read_b128 v[52:55], v245 offset:4352
    v_pk_add_i16 v8, v8, v12
    v_mfma_i32_16x16x64_i8 v[188:191], a[60:63], v[28:31], v[188:191]
    v_pk_add_i16 v9, v9, v13
    v_pk_add_i16 v10, v10, v14
    v_mfma_i32_16x16x64_i8 v[196:199], a[124:127], v[28:31], v[196:199]
    ds_read_b128 v[56:59], v245 offset:6144
    s_waitcnt lgkmcnt(3)
    v_mfma_i32_16x16x64_i8 v[200:203], a[0:3], v[32:35], v[112:115]
    buffer_store_dwordx2 v[106:107], v246, s[28:31], s75 offen offset:0 sc1 nt
    v_fma_f32 v110, v153, v72, v74
    v_mfma_i32_16x16x64_i8 v[208:211], a[64:67], v[32:35], v[112:115]
    ds_read_b128 v[60:63], v245 offset:6400
    v_fma_f32 v111, v157, v73, v75
    v_mfma_i32_16x16x64_i8 v[204:207], a[0:3], v[36:39], v[112:115]
    v_cvt_pk_bf16_f32 v94, v110, v111
    v_fma_f32 v110, v169, v76, v78
    v_mfma_i32_16x16x64_i8 v[212:215], a[64:67], v[36:39], v[112:115]
    ds_read_b128 v[16:19], v245 offset:8192
    v_fma_f32 v111, v173, v77, v79
    v_mfma_i32_16x16x64_i8 v[200:203], a[4:7], v[40:43], v[200:203]
    v_cvt_pk_bf16_f32 v95, v110, v111
    v_pk_add_i16 v11, v11, v15
    v_mfma_i32_16x16x64_i8 v[208:211], a[68:71], v[40:43], v[208:211]
    ds_read_b128 v[20:23], v245 offset:8448
    v_pk_add_i16 v8, v8, v10
    v_mfma_i32_16x16x64_i8 v[204:207], a[4:7], v[44:47], v[204:207]
    v_pk_add_i16 v9, v9, v11
    v_bfe_i32 v4, v8, 0, 16
    v_mfma_i32_16x16x64_i8 v[212:215], a[68:71], v[44:47], v[212:215]
    ds_read_b128 v[24:27], v245 offset:10240
    s_waitcnt lgkmcnt(3)
    v_mfma_i32_16x16x64_i8 v[200:203], a[8:11], v[48:51], v[200:203]
    buffer_store_dwordx2 v[92:93], v246, s[28:31], s68 offen offset:128 sc1 nt
    v_fma_f32 v110, v154, v72, v74
    v_mfma_i32_16x16x64_i8 v[208:211], a[72:75], v[48:51], v[208:211]
    ds_read_b128 v[28:31], v245 offset:10496
    v_fma_f32 v111, v158, v73, v75
    v_mfma_i32_16x16x64_i8 v[204:207], a[8:11], v[52:55], v[204:207]
    v_cvt_pk_bf16_f32 v96, v110, v111
    v_fma_f32 v110, v170, v76, v78
    v_mfma_i32_16x16x64_i8 v[212:215], a[72:75], v[52:55], v[212:215]
    ds_read_b128 v[32:35], v245 offset:12288
    v_fma_f32 v111, v174, v77, v79
    v_mfma_i32_16x16x64_i8 v[200:203], a[12:15], v[56:59], v[200:203]
    v_cvt_pk_bf16_f32 v97, v110, v111
    v_ashrrev_i32 v5, 16, v8
    v_mfma_i32_16x16x64_i8 v[208:211], a[76:79], v[56:59], v[208:211]
    ds_read_b128 v[36:39], v245 offset:12544
    v_bfe_i32 v6, v9, 0, 16
    v_mfma_i32_16x16x64_i8 v[204:207], a[12:15], v[60:63], v[204:207]
    v_ashrrev_i32 v7, 16, v9
    v_permlane32_swap_b32 v4, v5
    v_mfma_i32_16x16x64_i8 v[212:215], a[76:79], v[60:63], v[212:215]
    ds_read_b128 v[40:43], v245 offset:14336
    s_waitcnt lgkmcnt(3)
    v_mfma_i32_16x16x64_i8 v[200:203], a[16:19], v[16:19], v[200:203]
    s_nop 0
    v_permlane32_swap_b32 v6, v7
    v_mfma_i32_16x16x64_i8 v[208:211], a[80:83], v[16:19], v[208:211]
    ds_read_b128 v[44:47], v245 offset:14592
    v_add_u32 v4, v4, v5
    v_mfma_i32_16x16x64_i8 v[204:207], a[16:19], v[20:23], v[204:207]
    buffer_store_dwordx2 v[94:95], v246, s[28:31], s69 offen offset:128 sc1 nt
    v_fma_f32 v110, v155, v72, v74
    v_mfma_i32_16x16x64_i8 v[212:215], a[80:83], v[20:23], v[212:215]
    s_waitcnt vmcnt(18)
    s_barrier
    ds_read_b128 v[48:51], v245 offset:32768
    v_mfma_i32_16x16x64_i8 v[200:203], a[20:23], v[24:27], v[200:203]
    v_fma_f32 v111, v159, v73, v75
    v_cvt_pk_bf16_f32 v98, v110, v111
    v_mfma_i32_16x16x64_i8 v[208:211], a[84:87], v[24:27], v[208:211]
    ds_read_b128 v[52:55], v245 offset:33024
    v_fma_f32 v110, v171, v76, v78
    v_mfma_i32_16x16x64_i8 v[204:207], a[20:23], v[28:31], v[204:207]
    v_fma_f32 v111, v175, v77, v79
    v_cvt_pk_bf16_f32 v99, v110, v111
    v_mfma_i32_16x16x64_i8 v[212:215], a[84:87], v[28:31], v[212:215]
    ds_read_b128 v[56:59], v245 offset:34816
    s_waitcnt lgkmcnt(3)
    v_mfma_i32_16x16x64_i8 v[200:203], a[24:27], v[32:35], v[200:203]
    v_add_u32 v6, v6, v7
    s_nop 1
    v_mfma_i32_16x16x64_i8 v[208:211], a[88:91], v[32:35], v[208:211]
    ds_read_b128 v[60:63], v245 offset:35072
    v_permlane16_swap_b32 v4, v6
    v_mfma_i32_16x16x64_i8 v[204:207], a[24:27], v[36:39], v[204:207]
    buffer_store_dwordx2 v[96:97], v246, s[28:31], s70 offen offset:128 sc1 nt
    v_fma_f32 v110, v160, v72, v74
    v_mfma_i32_16x16x64_i8 v[212:215], a[88:91], v[36:39], v[212:215]
    ds_read_b128 v[16:19], v245 offset:36864
ISL2:
    s_cbranch_vccnz WARMRET
    v_fma_f32 v111, v164, v73, v75
    v_mfma_i32_16x16x64_i8 v[200:203], a[28:31], v[40:43], v[200:203]
    v_cvt_pk_bf16_f32 v100, v110, v111
    v_fma_f32 v110, v176, v76, v78
    v_mfma_i32_16x16x64_i8 v[208:211], a[92:95], v[40:43], v[208:211]
    ds_read_b128 v[20:23], v245 offset:37120
    v_fma_f32 v111, v180, v77, v79
    v_mfma_i32_16x16x64_i8 v[204:207], a[28:31], v[44:47], v[204:207]
    v_cvt_pk_bf16_f32 v101, v110, v111
    v_add_u32 v4, v4, v6
    v_mfma_i32_16x16x64_i8 v[212:215], a[92:95], v[44:47], v[212:215]
    ds_read_b128 v[24:27], v245 offset:38912
    s_waitcnt lgkmcnt(3)
    v_mfma_i32_16x16x64_i8 v[200:203], a[32:35], v[48:51], v[200:203]
    v_cvt_f32_i32 v4, v4
    v_cvt_pk_bf16_f32 v4, v4, v4
    v_mfma_i32_16x16x64_i8 v[208:211], a[96:99], v[48:51], v[208:211]
    ds_read_b128 v[28:31], v245 offset:39168
    v_lshlrev_b32 v4, 16, v4
    v_mfma_i32_16x16x64_i8 v[204:207], a[32:35], v[52:55], v[204:207]
    buffer_store_dwordx2 v[98:99], v246, s[28:31], s71 offen offset:128 sc1 nt
    v_fma_f32 v110, v161, v72, v74
    v_mfma_i32_16x16x64_i8 v[212:215], a[96:99], v[52:55], v[212:215]
    ds_read_b128 v[32:35], v245 offset:40960
    v_fma_f32 v111, v165, v73, v75
    v_mfma_i32_16x16x64_i8 v[200:203], a[36:39], v[56:59], v[200:203]
    v_cvt_pk_bf16_f32 v102, v110, v111
    v_fma_f32 v110, v177, v76, v78
    v_mfma_i32_16x16x64_i8 v[208:211], a[100:103], v[56:59], v[208:211]
    ds_read_b128 v[36:39], v245 offset:41216
    v_fma_f32 v111, v181, v77, v79
    v_mfma_i32_16x16x64_i8 v[204:207], a[36:39], v[60:63], v[204:207]
    v_cvt_pk_bf16_f32 v103, v110, v111
    v_mul_f32 v4, v4, v252
    v_mfma_i32_16x16x64_i8 v[212:215], a[100:103], v[60:63], v[212:215]
    ds_read_b128 v[40:43], v245 offset:43008
    s_waitcnt lgkmcnt(3)
    v_mfma_i32_16x16x64_i8 v[200:203], a[40:43], v[16:19], v[200:203]
    v_cvt_pk_bf16_f32 v4, v4, v4
    v_lshlrev_b32 v4, 16, v4
    v_mfma_i32_16x16x64_i8 v[208:211], a[104:107], v[16:19], v[208:211]
    ds_read_b128 v[44:47], v245 offset:43264
    v_fma_f32 v239, -v4, v238, v239
    v_mfma_i32_16x16x64_i8 v[204:207], a[40:43], v[20:23], v[204:207]
    v_fma_f32 v239, v238, s64, v239
    ds_write_b32 v250, v239 offset:1024
    v_mfma_i32_16x16x64_i8 v[212:215], a[104:107], v[20:23], v[212:215]
    ds_read_b128 v[48:51], v245 offset:45056
    v_or_b32 v116, v120, v121
    v_mfma_i32_16x16x64_i8 v[200:203], a[44:47], v[24:27], v[200:203]
    buffer_store_dwordx2 v[100:101], v246, s[28:31], s72 offen offset:128 sc1 nt
    v_fma_f32 v110, v162, v72, v74
    v_mfma_i32_16x16x64_i8 v[208:211], a[108:111], v[24:27], v[208:211]
    ds_read_b128 v[52:55], v245 offset:45312
    v_fma_f32 v111, v166, v73, v75
    v_mfma_i32_16x16x64_i8 v[204:207], a[44:47], v[28:31], v[204:207]
    v_cvt_pk_bf16_f32 v104, v110, v111
    v_fma_f32 v110, v178, v76, v78
    v_mfma_i32_16x16x64_i8 v[212:215], a[108:111], v[28:31], v[212:215]
    ds_read_b128 v[56:59], v245 offset:47104
    s_waitcnt lgkmcnt(4)
    v_mfma_i32_16x16x64_i8 v[200:203], a[48:51], v[32:35], v[200:203]
    v_fma_f32 v111, v182, v77, v79
    v_cvt_pk_bf16_f32 v105, v110, v111
    v_mfma_i32_16x16x64_i8 v[208:211], a[112:115], v[32:35], v[208:211]
    ds_read_b128 v[60:63], v245 offset:47360
    v_or_b32 v117, v122, v123
    v_mfma_i32_16x16x64_i8 v[204:207], a[48:51], v[36:39], v[204:207]
    v_or3_b32 v116, v116, v124, v125
    v_or3_b32 v117, v117, v126, v127
    v_mfma_i32_16x16x64_i8 v[212:215], a[112:115], v[36:39], v[212:215]
    s_waitcnt vmcnt(14) lgkmcnt(4)
    s_barrier
    ds_read_b128 v[16:19], v244 offset:16384
    v_mfma_i32_16x16x64_i8 v[200:203], a[52:55], v[40:43], v[200:203]
    buffer_store_dwordx2 v[102:103], v246, s[28:31], s73 offen offset:128 sc1 nt
    v_fma_f32 v110, v163, v72, v74
    v_mfma_i32_16x16x64_i8 v[208:211], a[116:119], v[40:43], v[208:211]
    ds_read_b128 v[20:23], v244 offset:16640
    v_fma_f32 v111, v167, v73, v75
    v_mfma_i32_16x16x64_i8 v[204:207], a[52:55], v[44:47], v[204:207]
    v_cvt_pk_bf16_f32 v106, v110, v111
    v_fma_f32 v110, v179, v76, v78
    v_mfma_i32_16x16x64_i8 v[212:215], a[116:119], v[44:47], v[212:215]
    ds_read_b128 v[24:27], v244 offset:18432
    s_waitcnt lgkmcnt(3)
    v_mfma_i32_16x16x64_i8 v[200:203], a[56:59], v[48:51], v[200:203]
    v_fma_f32 v111, v183, v77, v79
    v_cvt_pk_bf16_f32 v107, v110, v111
    v_mfma_i32_16x16x64_i8 v[208:211], a[120:123], v[48:51], v[208:211]
    ds_read_b128 v[28:31], v244 offset:18688
    v_or3_b32 v116, v116, v128, v129
    v_mfma_i32_16x16x64_i8 v[204:207], a[56:59], v[52:55], v[204:207]
    v_or3_b32 v117, v117, v130, v131
    v_or3_b32 v116, v116, v132, v133
    v_mfma_i32_16x16x64_i8 v[212:215], a[120:123], v[52:55], v[212:215]
    ds_read_b128 v[32:35], v244 offset:20480
    v_or3_b32 v117, v117, v134, v135
    v_mfma_i32_16x16x64_i8 v[200:203], a[60:63], v[56:59], v[200:203]
    buffer_store_dwordx2 v[104:105], v246, s[28:31], s74 offen offset:128 sc1 nt
    ds_read2_b32 v[82:83], v248 offset0:128 offset1:160
    v_mfma_i32_16x16x64_i8 v[208:211], a[124:127], v[56:59], v[208:211]
    ds_read_b128 v[36:39], v244 offset:20736
    ds_read2_b32 v[86:87], v248 offset0:144 offset1:176
    v_mfma_i32_16x16x64_i8 v[204:207], a[60:63], v[60:63], v[204:207]
    ds_read2_b32 v[90:91], v249 offset0:192 offset1:224
    s_waitcnt lgkmcnt(3)
    v_fma_f32 v110, v184, v80, v82
    v_mfma_i32_16x16x64_i8 v[212:215], a[124:127], v[60:63], v[212:215]
    ds_read_b128 v[40:43], v244 offset:22528
    v_fma_f32 v111, v188, v81, v83
    v_mfma_i32_16x16x64_i8 v[216:219], a[0:3], v[16:19], v[112:115]
    v_cvt_pk_bf16_f32 v92, v110, v111
    v_fma_f32 v110, v185, v80, v82
    v_mfma_i32_16x16x64_i8 v[224:227], a[64:67], v[16:19], v[112:115]
    ds_read_b128 v[44:47], v244 offset:22784
    v_fma_f32 v111, v189, v81, v83
    v_mfma_i32_16x16x64_i8 v[220:223], a[0:3], v[20:23], v[112:115]
    v_cvt_pk_bf16_f32 v94, v110, v111
    v_fma_f32 v110, v186, v80, v82
    v_mfma_i32_16x16x64_i8 v[228:231], a[64:67], v[20:23], v[112:115]
    ds_read_b128 v[48:51], v244 offset:24576
    v_fma_f32 v111, v190, v81, v83
    v_mfma_i32_16x16x64_i8 v[216:219], a[4:7], v[24:27], v[216:219]
    v_cvt_pk_bf16_f32 v96, v110, v111
    s_waitcnt lgkmcnt(4)
    v_fma_f32 v110, v200, v84, v86
    v_mfma_i32_16x16x64_i8 v[224:227], a[68:71], v[24:27], v[224:227]
    ds_read_b128 v[52:55], v244 offset:24832
    v_fma_f32 v111, v204, v85, v87
    v_mfma_i32_16x16x64_i8 v[220:223], a[4:7], v[28:31], v[220:223]
    buffer_store_dwordx2 v[106:107], v246, s[28:31], s75 offen offset:128 sc1 nt
    v_cvt_pk_bf16_f32 v93, v110, v111
    v_mfma_i32_16x16x64_i8 v[228:231], a[68:71], v[28:31], v[228:231]
    ds_read_b128 v[56:59], v244 offset:26624
    s_waitcnt lgkmcnt(3)
    v_mfma_i32_16x16x64_i8 v[216:219], a[8:11], v[32:35], v[216:219]
    v_fma_f32 v110, v201, v84, v86
    v_fma_f32 v111, v205, v85, v87
    v_mfma_i32_16x16x64_i8 v[224:227], a[72:75], v[32:35], v[224:227]
    ds_read_b128 v[60:63], v244 offset:26880
    v_cvt_pk_bf16_f32 v95, v110, v111
    v_mfma_i32_16x16x64_i8 v[220:223], a[8:11], v[36:39], v[220:223]
    v_or3_b32 v116, v116, v136, v137
    v_or3_b32 v117, v117, v138, v139
    v_mfma_i32_16x16x64_i8 v[228:231], a[72:75], v[36:39], v[228:231]
    ds_read_b128 v[16:19], v244 offset:28672
    v_or3_b32 v116, v116, v140, v141
    v_mfma_i32_16x16x64_i8 v[216:219], a[12:15], v[40:43], v[216:219]
    v_or3_b32 v117, v117, v142, v143
    v_or3_b32 v116, v116, v144, v145
    v_mfma_i32_16x16x64_i8 v[224:227], a[76:79], v[40:43], v[224:227]
    ds_read_b128 v[20:23], v244 offset:28928
    v_or3_b32 v117, v117, v146, v147
    v_mfma_i32_16x16x64_i8 v[220:223], a[12:15], v[44:47], v[220:223]
    buffer_store_dwordx2 v[92:93], v246, s[28:31], s68 offen offset:256 sc1 nt
    v_fma_f32 v110, v202, v84, v86
    v_mfma_i32_16x16x64_i8 v[228:231], a[76:79], v[44:47], v[228:231]
    ds_read_b128 v[24:27], v244 offset:30720
    s_waitcnt lgkmcnt(3)
    v_mfma_i32_16x16x64_i8 v[216:219], a[16:19], v[48:51], v[216:219]
    v_fma_f32 v111, v206, v85, v87
    v_cvt_pk_bf16_f32 v97, v110, v111
    v_mfma_i32_16x16x64_i8 v[224:227], a[80:83], v[48:51], v[224:227]
    ds_read_b128 v[28:31], v244 offset:30976
    v_or3_b32 v116, v116, v148, v149
    v_mfma_i32_16x16x64_i8 v[220:223], a[16:19], v[52:55], v[220:223]
    v_or3_b32 v117, v117, v150, v151
    v_or3_b32 v116, v116, v152, v153
    v_mfma_i32_16x16x64_i8 v[228:231], a[80:83], v[52:55], v[228:231]
    s_waitcnt vmcnt(12)
    s_barrier
    ds_read_b128 v[32:35], v244 offset:49152
    v_mfma_i32_16x16x64_i8 v[216:219], a[20:23], v[56:59], v[216:219]
    v_or3_b32 v117, v117, v154, v155
    v_or3_b32 v116, v116, v156, v157
    v_mfma_i32_16x16x64_i8 v[224:227], a[84:87], v[56:59], v[224:227]
    ds_read_b128 v[36:39], v244 offset:49408
    v_or3_b32 v117, v117, v158, v159
    v_mfma_i32_16x16x64_i8 v[220:223], a[20:23], v[60:63], v[220:223]
    buffer_store_dwordx2 v[94:95], v246, s[28:31], s69 offen offset:256 sc1 nt
    v_fma_f32 v110, v187, v80, v82
    v_mfma_i32_16x16x64_i8 v[228:231], a[84:87], v[60:63], v[228:231]
    ds_read_b128 v[40:43], v244 offset:51200
    s_waitcnt lgkmcnt(3)
    v_mfma_i32_16x16x64_i8 v[216:219], a[24:27], v[16:19], v[216:219]
    v_fma_f32 v111, v191, v81, v83
    v_cvt_pk_bf16_f32 v98, v110, v111
    v_mfma_i32_16x16x64_i8 v[224:227], a[88:91], v[16:19], v[224:227]
    ds_read_b128 v[44:47], v244 offset:51456
    v_fma_f32 v110, v203, v84, v86
    v_mfma_i32_16x16x64_i8 v[220:223], a[24:27], v[20:23], v[220:223]
    v_fma_f32 v111, v207, v85, v87
    v_cvt_pk_bf16_f32 v99, v110, v111
    v_mfma_i32_16x16x64_i8 v[228:231], a[88:91], v[20:23], v[228:231]
    ds_read_b128 v[48:51], v244 offset:53248
    v_or3_b32 v116, v116, v160, v161
    v_mfma_i32_16x16x64_i8 v[216:219], a[28:31], v[24:27], v[216:219]
    v_or3_b32 v117, v117, v162, v163
    v_or3_b32 v116, v116, v164, v165
    v_mfma_i32_16x16x64_i8 v[224:227], a[92:95], v[24:27], v[224:227]
    ds_read_b128 v[52:55], v244 offset:53504
    v_or3_b32 v117, v117, v166, v167
    v_mfma_i32_16x16x64_i8 v[220:223], a[28:31], v[28:31], v[220:223]
    buffer_store_dwordx2 v[96:97], v246, s[28:31], s70 offen offset:256 sc1 nt
    v_fma_f32 v110, v192, v80, v82
    v_mfma_i32_16x16x64_i8 v[228:231], a[92:95], v[28:31], v[228:231]
    ds_read_b128 v[56:59], v244 offset:55296
    s_waitcnt lgkmcnt(3)
    v_mfma_i32_16x16x64_i8 v[216:219], a[32:35], v[32:35], v[216:219]
    v_fma_f32 v111, v196, v81, v83
    v_cvt_pk_bf16_f32 v100, v110, v111
    v_mfma_i32_16x16x64_i8 v[224:227], a[96:99], v[32:35], v[224:227]
    ds_read_b128 v[60:63], v244 offset:55552
    ds_read_b128 a[128:131], v244 offset:57344
    v_mfma_i32_16x16x64_i8 v[220:223], a[32:35], v[36:39], v[220:223]
    v_fma_f32 v110, v208, v84, v86
    v_fma_f32 v111, v212, v85, v87
    v_mfma_i32_16x16x64_i8 v[228:231], a[96:99], v[36:39], v[228:231]
    ds_read_b128 a[132:135], v244 offset:57600
    ds_read_b128 a[136:139], v244 offset:59392
    v_mfma_i32_16x16x64_i8 v[216:219], a[36:39], v[40:43], v[216:219]
    v_cvt_pk_bf16_f32 v101, v110, v111
    v_or3_b32 v116, v116, v168, v169
    v_mfma_i32_16x16x64_i8 v[224:227], a[100:103], v[40:43], v[224:227]
    ds_read_b128 a[140:143], v244 offset:59648
    ds_read_b128 a[144:147], v244 offset:61440
    v_mfma_i32_16x16x64_i8 v[220:223], a[36:39], v[44:47], v[220:223]
    v_or3_b32 v117, v117, v170, v171
    v_or3_b32 v116, v116, v172, v173
    v_mfma_i32_16x16x64_i8 v[228:231], a[100:103], v[44:47], v[228:231]
    ds_read_b128 a[148:151], v244 offset:61696
    ds_read_b128 a[152:155], v244 offset:63488
    s_waitcnt lgkmcnt(7)
    v_mfma_i32_16x16x64_i8 v[216:219], a[40:43], v[48:51], v[216:219]
    buffer_store_dwordx2 v[98:99], v246, s[28:31], s71 offen offset:256 sc1 nt
    v_fma_f32 v110, v193, v80, v82
    v_mfma_i32_16x16x64_i8 v[224:227], a[104:107], v[48:51], v[224:227]
    ds_read_b128 a[156:159], v244 offset:63744
    v_fma_f32 v111, v197, v81, v83
    v_mfma_i32_16x16x64_i8 v[220:223], a[40:43], v[52:55], v[220:223]
    v_cvt_pk_bf16_f32 v102, v110, v111
    v_fma_f32 v110, v209, v84, v86
    v_mfma_i32_16x16x64_i8 v[228:231], a[104:107], v[52:55], v[228:231]
    v_fma_f32 v111, v213, v85, v87
    v_cvt_pk_bf16_f32 v103, v110, v111
    v_mfma_i32_16x16x64_i8 v[216:219], a[44:47], v[56:59], v[216:219]
    v_or3_b32 v117, v117, v174, v175
    v_or3_b32 v116, v116, v176, v177
    v_mfma_i32_16x16x64_i8 v[224:227], a[108:111], v[56:59], v[224:227]
    v_or3_b32 v117, v117, v178, v179
    v_or3_b32 v116, v116, v180, v181
    v_mfma_i32_16x16x64_i8 v[220:223], a[44:47], v[60:63], v[220:223]
    v_or3_b32 v117, v117, v182, v183
    v_or3_b32 v116, v116, v184, v185
    v_mfma_i32_16x16x64_i8 v[228:231], a[108:111], v[60:63], v[228:231]
    s_waitcnt lgkmcnt(4)
    v_or3_b32 v117, v117, v186, v187
    v_mfma_i32_16x16x64_i8 v[216:219], a[48:51], a[128:131], v[216:219]
    buffer_store_dwordx2 v[100:101], v246, s[28:31], s72 offen offset:256 sc1 nt
    v_fma_f32 v110, v194, v80, v82
    v_mfma_i32_16x16x64_i8 v[220:223], a[48:51], a[132:135], v[220:223]
    v_fma_f32 v111, v198, v81, v83
    v_cvt_pk_bf16_f32 v104, v110, v111
    v_mfma_i32_16x16x64_i8 v[216:219], a[52:55], a[136:139], v[216:219]
    v_fma_f32 v110, v210, v84, v86
    v_fma_f32 v111, v214, v85, v87
    v_mfma_i32_16x16x64_i8 v[220:223], a[52:55], a[140:143], v[220:223]
    s_waitcnt lgkmcnt(0)
    v_cvt_pk_bf16_f32 v105, v110, v111
    v_mfma_i32_16x16x64_i8 v[216:219], a[56:59], a[144:147], v[216:219]
    v_or3_b32 v116, v116, v188, v189
    v_or3_b32 v117, v117, v190, v191
    v_mfma_i32_16x16x64_i8 v[220:223], a[56:59], a[148:151], v[220:223]
    v_or3_b32 v116, v116, v192, v193
    v_or3_b32 v117, v117, v194, v195
    v_mfma_i32_16x16x64_i8 v[216:219], a[60:63], a[152:155], v[216:219]
    v_or3_b32 v116, v116, v196, v197
    v_or3_b32 v117, v117, v198, v199
    v_mfma_i32_16x16x64_i8 v[220:223], a[60:63], a[156:159], v[220:223]
    v_mfma_i32_16x16x64_i8 v[224:227], a[112:115], a[128:131], v[224:227]
    buffer_store_dwordx2 v[102:103], v246, s[28:31], s73 offen offset:256 sc1 nt
    v_fma_f32 v110, v195, v80, v82
    v_mfma_i32_16x16x64_i8 v[228:231], a[112:115], a[132:135], v[228:231]
    v_fma_f32 v111, v199, v81, v83
    v_cvt_pk_bf16_f32 v106, v110, v111
    v_mfma_i32_16x16x64_i8 v[224:227], a[116:119], a[136:139], v[224:227]
    v_fma_f32 v110, v211, v84, v86
    v_fma_f32 v111, v215, v85, v87
    v_mfma_i32_16x16x64_i8 v[228:231], a[116:119], a[140:143], v[228:231]
    v_cvt_pk_bf16_f32 v107, v110, v111
    v_or3_b32 v116, v116, v200, v201
    v_mfma_i32_16x16x64_i8 v[224:227], a[120:123], a[144:147], v[224:227]
    v_or3_b32 v117, v117, v202, v203
    v_or3_b32 v116, v116, v204, v205
    v_mfma_i32_16x16x64_i8 v[228:231], a[120:123], a[148:151], v[228:231]
    v_or3_b32 v117, v117, v206, v207
    v_or3_b32 v116, v116, v208, v209
    v_mfma_i32_16x16x64_i8 v[224:227], a[124:127], a[152:155], v[224:227]
    v_or3_b32 v117, v117, v210, v211
    v_or3_b32 v116, v116, v212, v213
    v_mfma_i32_16x16x64_i8 v[228:231], a[124:127], a[156:159], v[228:231]
    buffer_store_dwordx2 v[104:105], v246, s[28:31], s74 offen offset:256 sc1 nt
    buffer_store_dwordx2 v[106:107], v246, s[28:31], s75 offen offset:256 sc1 nt
    v_fma_f32 v110, v216, v88, v90
    v_fma_f32 v111, v220, v89, v91
    v_cvt_pk_bf16_f32 v92, v110, v111
    buffer_store_dword v92, v247, s[28:31], s68 offen offset:0 sc1 nt
    v_fma_f32 v110, v217, v88, v90
    v_fma_f32 v111, v221, v89, v91
    v_cvt_pk_bf16_f32 v94, v110, v111
    buffer_store_dword v94, v247, s[28:31], s69 offen offset:0 sc1 nt
    v_fma_f32 v110, v218, v88, v90
    v_fma_f32 v111, v222, v89, v91
    v_cvt_pk_bf16_f32 v96, v110, v111
    buffer_store_dword v96, v247, s[28:31], s70 offen offset:0 sc1 nt
    v_fma_f32 v110, v219, v88, v90
    v_fma_f32 v111, v223, v89, v91
    v_cvt_pk_bf16_f32 v98, v110, v111
    buffer_store_dword v98, v247, s[28:31], s71 offen offset:0 sc1 nt
    v_fma_f32 v110, v224, v88, v90
    v_fma_f32 v111, v228, v89, v91
    v_cvt_pk_bf16_f32 v100, v110, v111
    buffer_store_dword v100, v247, s[28:31], s72 offen offset:0 sc1 nt
    v_fma_f32 v110, v225, v88, v90
    v_fma_f32 v111, v229, v89, v91
    v_cvt_pk_bf16_f32 v102, v110, v111
    buffer_store_dword v102, v247, s[28:31], s73 offen offset:0 sc1 nt
    v_fma_f32 v110, v226, v88, v90
    v_fma_f32 v111, v230, v89, v91
    v_cvt_pk_bf16_f32 v104, v110, v111
    buffer_store_dword v104, v247, s[28:31], s74 offen offset:0 sc1 nt
    v_fma_f32 v110, v227, v88, v90
    v_fma_f32 v111, v231, v89, v91
    v_cvt_pk_bf16_f32 v106, v110, v111
    buffer_store_dword v106, v247, s[28:31], s75 offen offset:0 sc1 nt
    v_or3_b32 v117, v117, v214, v215
    s_mov_b32 s34, 0x03800000
    v_or3_b32 v116, v116, v216, v217
    v_or3_b32 v117, v117, v218, v219
    v_or3_b32 v116, v116, v220, v221
    v_or3_b32 v117, v117, v222, v223
    v_or_b32 v116, v116, v117
    v_or3_b32 v117, v224, v225, v226
    v_or3_b32 v116, v116, v227, v228
    v_or3_b32 v117, v117, v229, v230
    v_or3_b32 v116, v116, v117, v231
    v_and_b32 v116, s34, v116
    v_cmp_ne_u32 vcc, 0, v116
    s_cbranch_vccnz WIDE
K_END:
    s_endpgm
PO1_SLOW:
    s_mov_b32 s55, 200000
PO1_RETRY:
    s_sleep 1
    buffer_load_dword v236, v233, s[16:19], s53 offen sc1
    s_sub_u32 s55, s55, 1
    s_cmp_eq_u32 s55, 0
    s_cbranch_scc1 PO1_OUT
    s_waitcnt vmcnt(0)
    v_cmp_ne_u32 vcc, s43, v236
    s_nop 0
    s_cmp_lg_u64 vcc, 0
    s_cbranch_scc1 PO1_RETRY
PO1_OUT:
    s_mov_b64 vcc, 0
    s_branch PO1_OK
PO2_SLOW:
    s_mov_b32 s55, 200000
PO2_RETRY:
    s_sleep 1
    buffer_load_dword v236, v233, s[16:19], s53 offen sc1
    s_sub_u32 s55, s55, 1
    s_cmp_eq_u32 s55, 0
    s_cbranch_scc1 PO2_OUT
    s_waitcnt vmcnt(0)
    v_cmp_ne_u32 vcc, s43, v236
    s_nop 0
    s_cmp_lg_u64 vcc, 0
    s_cbranch_scc1 PO2_RETRY
PO2_OUT:
    s_mov_b64 vcc, 0
    s_branch PO2_OK
PO3_SLOW:
    s_mov_b32 s55, 200000
PO3_RETRY:
    s_sleep 1
    buffer_load_dword v236, v233, s[16:19], s53 offen sc1
    s_sub_u32 s55, s55, 1
    s_cmp_eq_u32 s55, 0
    s_cbranch_scc1 PO3_OUT
    s_waitcnt vmcnt(0)
    v_cmp_ne_u32 vcc, s43, v236
    s_nop 0
    s_cmp_lg_u64 vcc, 0
    s_cbranch_scc1 PO3_RETRY
PO3_OUT:
    s_mov_b64 vcc, 0
    s_branch PO3_OK
PO4_SLOW:
    s_mov_b32 s55, 200000
PO4_RETRY:
    s_sleep 1
    buffer_load_dword v236, v234, s[16:19], s53 offen sc1
    s_sub_u32 s55, s55, 1
    s_cmp_eq_u32 s55, 0
    s_cbranch_scc1 PO4_OUT
    s_waitcnt vmcnt(0)
    v_cmp_ne_u32 vcc, s43, v236
    s_nop 0
    s_cmp_lg_u64 vcc, 0
    s_cbranch_scc1 PO4_RETRY
PO4_OUT:
    s_mov_b64 vcc, 0
    s_branch PO4_OK
WIDE:
    s_waitcnt vmcnt(0)
    s_mov_b32 s34, 0x34800000
    v_sub_u32 v120, v120, v112
    v_cvt_f32_i32 v120, v120
    v_fma_f32 v120, v120, s34, v112
    v_sub_u32 v121, v121, v112
    v_cvt_f32_i32 v121, v121
    v_fma_f32 v121, v121, s34, v112
    v_sub_u32 v122, v122, v112
    v_cvt_f32_i32 v122, v122
    v_fma_f32 v122, v122, s34, v112
    v_sub_u32 v123, v123, v112
    v_cvt_f32_i32 v123, v123
    v_fma_f32 v123, v123, s34, v112
    v_sub_u32 v124, v124, v112
    v_cvt_f32_i32 v124, v124
    v_fma_f32 v124, v124, s34, v112
    v_sub_u32 v125, v125, v112
    v_cvt_f32_i32 v125, v125
    v_fma_f32 v125, v125, s34, v112
    v_sub_u32 v126, v126, v112
    v_cvt_f32_i32 v126, v126
    v_fma_f32 v126, v126, s34, v112
    v_sub_u32 v127, v127, v112
    v_cvt_f32_i32 v127, v127
    v_fma_f32 v127, v127, s34, v112
    v_sub_u32 v128, v128, v112
    v_cvt_f32_i32 v128, v128
    v_fma_f32 v128, v128, s34, v112
    v_sub_u32 v129, v129, v112
    v_cvt_f32_i32 v129, v129
    v_fma_f32 v129, v129, s34, v112
    v_sub_u32 v130, v130, v112
    v_cvt_f32_i32 v130, v130
    v_fma_f32 v130, v130, s34, v112
    v_sub_u32 v131, v131, v112
    v_cvt_f32_i32 v131, v131
    v_fma_f32 v131, v131, s34, v112
    v_sub_u32 v132, v132, v112
    v_cvt_f32_i32 v132, v132
    v_fma_f32 v132, v132, s34, v112
    v_sub_u32 v133, v133, v112
    v_cvt_f32_i32 v133, v133
    v_fma_f32 v133, v133, s34, v112
    v_sub_u32 v134, v134, v112
    v_cvt_f32_i32 v134, v134
    v_fma_f32 v134, v134, s34, v112
    v_sub_u32 v135, v135, v112
    v_cvt_f32_i32 v135, v135
    v_fma_f32 v135, v135, s34, v112
    v_sub_u32 v136, v136, v112
    v_cvt_f32_i32 v136, v136
    v_fma_f32 v136, v136, s34, v112
    v_sub_u32 v137, v137, v112
    v_cvt_f32_i32 v137, v137
    v_fma_f32 v137, v137, s34, v112
    v_sub_u32 v138, v138, v112
    v_cvt_f32_i32 v138, v138
    v_fma_f32 v138, v138, s34, v112
    v_sub_u32 v139, v139, v112
    v_cvt_f32_i32 v139, v139
    v_fma_f32 v139, v139, s34, v112
    v_sub_u32 v140, v140, v112
    v_cvt_f32_i32 v140, v140
    v_fma_f32 v140, v140, s34, v112
    v_sub_u32 v141, v141, v112
    v_cvt_f32_i32 v141, v141
    v_fma_f32 v141, v141, s34, v112
    v_sub_u32 v142, v142, v112
    v_cvt_f32_i32 v142, v142
    v_fma_f32 v142, v142, s34, v112
    v_sub_u32 v143, v143, v112
    v_cvt_f32_i32 v143, v143
    v_fma_f32 v143, v143, s34, v112
    v_sub_u32 v144, v144, v112
    v_cvt_f32_i32 v144, v144
    v_fma_f32 v144, v144, s34, v112
    v_sub_u32 v145, v145, v112
    v_cvt_f32_i32 v145, v145
    v_fma_f32 v145, v145, s34, v112
    v_sub_u32 v146, v146, v112
    v_cvt_f32_i32 v146, v146
    v_fma_f32 v146, v146, s34, v112
    v_sub_u32 v147, v147, v112
    v_cvt_f32_i32 v147, v147
    v_fma_f32 v147, v147, s34, v112
    v_sub_u32 v148, v148, v112
    v_cvt_f32_i32 v148, v148
    v_fma_f32 v148, v148, s34, v112
    v_sub_u32 v149, v149, v112
    v_cvt_f32_i32 v149, v149
    v_fma_f32 v149, v149, s34, v112
    v_sub_u32 v150, v150, v112
    v_cvt_f32_i32 v150, v150
    v_fma_f32 v150, v150, s34, v112
    v_sub_u32 v151, v151, v112
    v_cvt_f32_i32 v151, v151
    v_fma_f32 v151, v151, s34, v112
    v_sub_u32 v152, v152, v112
    v_cvt_f32_i32 v152, v152
    v_fma_f32 v152, v152, s34, v112
    v_sub_u32 v153, v153, v112
    v_cvt_f32_i32 v153, v153
    v_fma_f32 v153, v153, s34, v112
    v_sub_u32 v154, v154, v112
    v_cvt_f32_i32 v154, v154
    v_fma_f32 v154, v154, s34, v112
    v_sub_u32 v155, v155, v112
    v_cvt_f32_i32 v155, v155
    v_fma_f32 v155, v155, s34, v112
    v_sub_u32 v156, v156, v112
    v_cvt_f32_i32 v156, v156
    v_fma_f32 v156, v156, s34, v112
    v_sub_u32 v157, v157, v112
    v_cvt_f32_i32 v157, v157
    v_fma_f32 v157, v157, s34, v112
    v_sub_u32 v158, v158, v112
    v_cvt_f32_i32 v158, v158
    v_fma_f32 v158, v158, s34, v112
    v_sub_u32 v159, v159, v112
    v_cvt_f32_i32 v159, v159
    v_fma_f32 v159, v159, s34, v112
    v_sub_u32 v160, v160, v112
    v_cvt_f32_i32 v160, v160
    v_fma_f32 v160, v160, s34, v112
    v_sub_u32 v161, v161, v112
    v_cvt_f32_i32 v161, v161
    v_fma_f32 v161, v161, s34, v112
    v_sub_u32 v162, v162, v112
    v_cvt_f32_i32 v162, v162
    v_fma_f32 v162, v162, s34, v112
    v_sub_u32 v163, v163, v112
    v_cvt_f32_i32 v163, v163
    v_fma_f32 v163, v163, s34, v112
    v_sub_u32 v164, v164, v112
    v_cvt_f32_i32 v164, v164
    v_fma_f32 v164, v164, s34, v112
    v_sub_u32 v165, v165, v112
    v_cvt_f32_i32 v165, v165
    v_fma_f32 v165, v165, s34, v112
    v_sub_u32 v166, v166, v112
    v_cvt_f32_i32 v166, v166
    v_fma_f32 v166, v166, s34, v112
    v_sub_u32 v167, v167, v112
    v_cvt_f32_i32 v167, v167
    v_fma_f32 v167, v167, s34, v112
    v_sub_u32 v168, v168, v112
    v_cvt_f32_i32 v168, v168
    v_fma_f32 v168, v168, s34, v112
    v_sub_u32 v169, v169, v112
    v_cvt_f32_i32 v169, v169
    v_fma_f32 v169, v169, s34, v112
    v_sub_u32 v170, v170, v112
    v_cvt_f32_i32 v170, v170
    v_fma_f32 v170, v170, s34, v112
    v_sub_u32 v171, v171, v112
    v_cvt_f32_i32 v171, v171
    v_fma_f32 v171, v171, s34, v112
    v_sub_u32 v172, v172, v112
    v_cvt_f32_i32 v172, v172
    v_fma_f32 v172, v172, s34, v112
    v_sub_u32 v173, v173, v112
    v_cvt_f32_i32 v173, v173
    v_fma_f32 v173, v173, s34, v112
    v_sub_u32 v174, v174, v112
    v_cvt_f32_i32 v174, v174
    v_fma_f32 v174, v174, s34, v112
    v_sub_u32 v175, v175, v112
    v_cvt_f32_i32 v175, v175
    v_fma_f32 v175, v175, s34, v112
    v_sub_u32 v176, v176, v112
    v_cvt_f32_i32 v176, v176
    v_fma_f32 v176, v176, s34, v112
    v_sub_u32 v177, v177, v112
    v_cvt_f32_i32 v177, v177
    v_fma_f32 v177, v177, s34, v112
    v_sub_u32 v178, v178, v112
    v_cvt_f32_i32 v178, v178
    v_fma_f32 v178, v178, s34, v112
    v_sub_u32 v179, v179, v112
    v_cvt_f32_i32 v179, v179
    v_fma_f32 v179, v179, s34, v112
    v_sub_u32 v180, v180, v112
    v_cvt_f32_i32 v180, v180
    v_fma_f32 v180, v180, s34, v112
    v_sub_u32 v181, v181, v112
    v_cvt_f32_i32 v181, v181
    v_fma_f32 v181, v181, s34, v112
    v_sub_u32 v182, v182, v112
    v_cvt_f32_i32 v182, v182
    v_fma_f32 v182, v182, s34, v112
    v_sub_u32 v183, v183, v112
    v_cvt_f32_i32 v183, v183
    v_fma_f32 v183, v183, s34, v112
    v_sub_u32 v184, v184, v112
    v_cvt_f32_i32 v184, v184
    v_fma_f32 v184, v184, s34, v112
    v_sub_u32 v185, v185, v112
    v_cvt_f32_i32 v185, v185
    v_fma_f32 v185, v185, s34, v112
    v_sub_u32 v186, v186, v112
    v_cvt_f32_i32 v186, v186
    v_fma_f32 v186, v186, s34, v112
    v_sub_u32 v187, v187, v112
    v_cvt_f32_i32 v187, v187
    v_fma_f32 v187, v187, s34, v112
    v_sub_u32 v188, v188, v112
    v_cvt_f32_i32 v188, v188
    v_fma_f32 v188, v188, s34, v112
    v_sub_u32 v189, v189, v112
    v_cvt_f32_i32 v189, v189
    v_fma_f32 v189, v189, s34, v112
    v_sub_u32 v190, v190, v112
    v_cvt_f32_i32 v190, v190
    v_fma_f32 v190, v190, s34, v112
    v_sub_u32 v191, v191, v112
    v_cvt_f32_i32 v191, v191
    v_fma_f32 v191, v191, s34, v112
    v_sub_u32 v192, v192, v112
    v_cvt_f32_i32 v192, v192
    v_fma_f32 v192, v192, s34, v112
    v_sub_u32 v193, v193, v112
    v_cvt_f32_i32 v193, v193
    v_fma_f32 v193, v193, s34, v112
    v_sub_u32 v194, v194, v112
    v_cvt_f32_i32 v194, v194
    v_fma_f32 v194, v194, s34, v112
    v_sub_u32 v195, v195, v112
    v_cvt_f32_i32 v195, v195
    v_fma_f32 v195, v195, s34, v112
    v_sub_u32 v196, v196, v112
    v_cvt_f32_i32 v196, v196
    v_fma_f32 v196, v196, s34, v112
    v_sub_u32 v197, v197, v112
    v_cvt_f32_i32 v197, v197
    v_fma_f32 v197, v197, s34, v112
    v_sub_u32 v198, v198, v112
    v_cvt_f32_i32 v198, v198
    v_fma_f32 v198, v198, s34, v112
    v_sub_u32 v199, v199, v112
    v_cvt_f32_i32 v199, v199
    v_fma_f32 v199, v199, s34, v112
    v_sub_u32 v200, v200, v112
    v_cvt_f32_i32 v200, v200
    v_fma_f32 v200, v200, s34, v112
    v_sub_u32 v201, v201, v112
    v_cvt_f32_i32 v201, v201
    v_fma_f32 v201, v201, s34, v112
    v_sub_u32 v202, v202, v112
    v_cvt_f32_i32 v202, v202
    v_fma_f32 v202, v202, s34, v112
    v_sub_u32 v203, v203, v112
    v_cvt_f32_i32 v203, v203
    v_fma_f32 v203, v203, s34, v112
    v_sub_u32 v204, v204, v112
    v_cvt_f32_i32 v204, v204
    v_fma_f32 v204, v204, s34, v112
    v_sub_u32 v205, v205, v112
    v_cvt_f32_i32 v205, v205
    v_fma_f32 v205, v205, s34, v112
    v_sub_u32 v206, v206, v112
    v_cvt_f32_i32 v206, v206
    v_fma_f32 v206, v206, s34, v112
    v_sub_u32 v207, v207, v112
    v_cvt_f32_i32 v207, v207
    v_fma_f32 v207, v207, s34, v112
    v_sub_u32 v208, v208, v112
    v_cvt_f32_i32 v208, v208
    v_fma_f32 v208, v208, s34, v112
    v_sub_u32 v209, v209, v112
    v_cvt_f32_i32 v209, v209
    v_fma_f32 v209, v209, s34, v112
    v_sub_u32 v210, v210, v112
    v_cvt_f32_i32 v210, v210
    v_fma_f32 v210, v210, s34, v112
    v_sub_u32 v211, v211, v112
    v_cvt_f32_i32 v211, v211
    v_fma_f32 v211, v211, s34, v112
    v_sub_u32 v212, v212, v112
    v_cvt_f32_i32 v212, v212
    v_fma_f32 v212, v212, s34, v112
    v_sub_u32 v213, v213, v112
    v_cvt_f32_i32 v213, v213
    v_fma_f32 v213, v213, s34, v112
    v_sub_u32 v214, v214, v112
    v_cvt_f32_i32 v214, v214
    v_fma_f32 v214, v214, s34, v112
    v_sub_u32 v215, v215, v112
    v_cvt_f32_i32 v215, v215
    v_fma_f32 v215, v215, s34, v112
    v_sub_u32 v216, v216, v112
    v_cvt_f32_i32 v216, v216
    v_fma_f32 v216, v216, s34, v112
    v_sub_u32 v217, v217, v112
    v_cvt_f32_i32 v217, v217
    v_fma_f32 v217, v217, s34, v112
    v_sub_u32 v218, v218, v112
    v_cvt_f32_i32 v218, v218
    v_fma_f32 v218, v218, s34, v112
    v_sub_u32 v219, v219, v112
    v_cvt_f32_i32 v219, v219
    v_fma_f32 v219, v219, s34, v112
    v_sub_u32 v220, v220, v112
    v_cvt_f32_i32 v220, v220
    v_fma_f32 v220, v220, s34, v112
    v_sub_u32 v221, v221, v112
    v_cvt_f32_i32 v221, v221
    v_fma_f32 v221, v221, s34, v112
    v_sub_u32 v222, v222, v112
    v_cvt_f32_i32 v222, v222
    v_fma_f32 v222, v222, s34, v112
    v_sub_u32 v223, v223, v112
    v_cvt_f32_i32 v223, v223
    v_fma_f32 v223, v223, s34, v112
    v_sub_u32 v224, v224, v112
    v_cvt_f32_i32 v224, v224
    v_fma_f32 v224, v224, s34, v112
    v_sub_u32 v225, v225, v112
    v_cvt_f32_i32 v225, v225
    v_fma_f32 v225, v225, s34, v112
    v_sub_u32 v226, v226, v112
    v_cvt_f32_i32 v226, v226
    v_fma_f32 v226, v226, s34, v112
    v_sub_u32 v227, v227, v112
    v_cvt_f32_i32 v227, v227
    v_fma_f32 v227, v227, s34, v112
    v_sub_u32 v228, v228, v112
    v_cvt_f32_i32 v228, v228
    v_fma_f32 v228, v228, s34, v112
    v_sub_u32 v229, v229, v112
    v_cvt_f32_i32 v229, v229
    v_fma_f32 v229, v229, s34, v112
    v_sub_u32 v230, v230, v112
    v_cvt_f32_i32 v230, v230
    v_fma_f32 v230, v230, s34, v112
    v_sub_u32 v231, v231, v112
    v_cvt_f32_i32 v231, v231
    v_fma_f32 v231, v231, s34, v112
    v_fma_f32 v110, v120, v64, v66
    v_fma_f32 v111, v124, v65, v67
    v_cvt_pk_bf16_f32 v92, v110, v111
    v_fma_f32 v110, v121, v64, v66
    v_fma_f32 v111, v125, v65, v67
    v_cvt_pk_bf16_f32 v94, v110, v111
    v_fma_f32 v110, v122, v64, v66
    v_fma_f32 v111, v126, v65, v67
    v_cvt_pk_bf16_f32 v96, v110, v111
    v_fma_f32 v110, v123, v64, v66
    v_fma_f32 v111, v127, v65, v67
    v_cvt_pk_bf16_f32 v98, v110, v111
    v_fma_f32 v110, v128, v64, v66
    v_fma_f32 v111, v132, v65, v67
    v_cvt_pk_bf16_f32 v100, v110, v111
    v_fma_f32 v110, v129, v64, v66
    v_fma_f32 v111, v133, v65, v67
    v_cvt_pk_bf16_f32 v102, v110, v111
    v_fma_f32 v110, v130, v64, v66
    v_fma_f32 v111, v134, v65, v67
    v_cvt_pk_bf16_f32 v104, v110, v111
    v_fma_f32 v110, v131, v64, v66
    v_fma_f32 v111, v135, v65, v67
    v_cvt_pk_bf16_f32 v106, v110, v111
    v_fma_f32 v110, v136, v68, v70
    v_fma_f32 v111, v140, v69, v71
    v_cvt_pk_bf16_f32 v93, v110, v111
    buffer_store_dwordx2 v[92:93], v246, s[28:31], s68 offen offset:0 sc1 nt
    v_fma_f32 v110, v137, v68, v70
    v_fma_f32 v111, v141, v69, v71
    v_cvt_pk_bf16_f32 v95, v110, v111
    buffer_store_dwordx2 v[94:95], v246, s[28:31], s69 offen offset:0 sc1 nt
    v_fma_f32 v110, v138, v68, v70
    v_fma_f32 v111, v142, v69, v71
    v_cvt_pk_bf16_f32 v97, v110, v111
    buffer_store_dwordx2 v[96:97], v246, s[28:31], s70 offen offset:0 sc1 nt
    v_fma_f32 v110, v139, v68, v70
    v_fma_f32 v111, v143, v69, v71
    v_cvt_pk_bf16_f32 v99, v110, v111
    buffer_store_dwordx2 v[98:99], v246, s[28:31], s71 offen offset:0 sc1 nt
    v_fma_f32 v110, v144, v68, v70
    v_fma_f32 v111, v148, v69, v71
    v_cvt_pk_bf16_f32 v101, v110, v111
    buffer_store_dwordx2 v[100:101], v246, s[28:31], s72 offen offset:0 sc1 nt
    v_fma_f32 v110, v145, v68, v70
    v_fma_f32 v111, v149, v69, v71
    v_cvt_pk_bf16_f32 v103, v110, v111
    buffer_store_dwordx2 v[102:103], v246, s[28:31], s73 offen offset:0 sc1 nt
    v_fma_f32 v110, v146, v68, v70
    v_fma_f32 v111, v150, v69, v71
    v_cvt_pk_bf16_f32 v105, v110, v111
    buffer_store_dwordx2 v[104:105], v246, s[28:31], s74 offen offset:0 sc1 nt
    v_fma_f32 v110, v147, v68, v70
    v_fma_f32 v111, v151, v69, v71
    v_cvt_pk_bf16_f32 v107, v110, v111
    buffer_store_dwordx2 v[106:107], v246, s[28:31], s75 offen offset:0 sc1 nt
    s_waitcnt vmcnt(0)
    v_fma_f32 v110, v152, v72, v74
    v_fma_f32 v111, v156, v73, v75
    v_cvt_pk_bf16_f32 v92, v110, v111
    v_fma_f32 v110, v153, v72, v74
    v_fma_f32 v111, v157, v73, v75
    v_cvt_pk_bf16_f32 v94, v110, v111
    v_fma_f32 v110, v154, v72, v74
    v_fma_f32 v111, v158, v73, v75
    v_cvt_pk_bf16_f32 v96, v110, v111
    v_fma_f32 v110, v155, v72, v74
    v_fma_f32 v111, v159, v73, v75
    v_cvt_pk_bf16_f32 v98, v110, v111
    v_fma_f32 v110, v160, v72, v74
    v_fma_f32 v111, v164, v73, v75
    v_cvt_pk_bf16_f32 v100, v110, v111
    v_fma_f32 v110, v161, v72, v74
    v_fma_f32 v111, v165, v73, v75
    v_cvt_pk_bf16_f32 v102, v110, v111
    v_fma_f32 v110, v162, v72, v74
    v_fma_f32 v111, v166, v73, v75
    v_cvt_pk_bf16_f32 v104, v110, v111
    v_fma_f32 v110, v163, v72, v74
    v_fma_f32 v111, v167, v73, v75
    v_cvt_pk_bf16_f32 v106, v110, v111
    v_fma_f32 v110, v168, v76, v78
    v_fma_f32 v111, v172, v77, v79
    v_cvt_pk_bf16_f32 v93, v110, v111
    buffer_store_dwordx2 v[92:93], v246, s[28:31], s68 offen offset:128 sc1 nt
    v_fma_f32 v110, v169, v76, v78
    v_fma_f32 v111, v173, v77, v79
    v_cvt_pk_bf16_f32 v95, v110, v111
    buffer_store_dwordx2 v[94:95], v246, s[28:31], s69 offen offset:128 sc1 nt
    v_fma_f32 v110, v170, v76, v78
    v_fma_f32 v111, v174, v77, v79
    v_cvt_pk_bf16_f32 v97, v110, v111
    buffer_store_dwordx2 v[96:97], v246, s[28:31], s70 offen offset:128 sc1 nt
    v_fma_f32 v110, v171, v76, v78
    v_fma_f32 v111, v175, v77, v79
    v_cvt_pk_bf16_f32 v99, v110, v111
    buffer_store_dwordx2 v[98:99], v246, s[28:31], s71 offen offset:128 sc1 nt
    v_fma_f32 v110, v176, v76, v78
    v_fma_f32 v111, v180, v77, v79
    v_cvt_pk_bf16_f32 v101, v110, v111
    buffer_store_dwordx2 v[100:101], v246, s[28:31], s72 offen offset:128 sc1 nt
    v_fma_f32 v110, v177, v76, v78
    v_fma_f32 v111, v181, v77, v79
    v_cvt_pk_bf16_f32 v103, v110, v111
    buffer_store_dwordx2 v[102:103], v246, s[28:31], s73 offen offset:128 sc1 nt
    v_fma_f32 v110, v178, v76, v78
    v_fma_f32 v111, v182, v77, v79
    v_cvt_pk_bf16_f32 v105, v110, v111
    buffer_store_dwordx2 v[104:105], v246, s[28:31], s74 offen offset:128 sc1 nt
    v_fma_f32 v110, v179, v76, v78
    v_fma_f32 v111, v183, v77, v79
    v_cvt_pk_bf16_f32 v107, v110, v111
    buffer_store_dwordx2 v[106:107], v246, s[28:31], s75 offen offset:128 sc1 nt
    s_waitcnt vmcnt(0)
    v_fma_f32 v110, v184, v80, v82
    v_fma_f32 v111, v188, v81, v83
    v_cvt_pk_bf16_f32 v92, v110, v111
    v_fma_f32 v110, v185, v80, v82
    v_fma_f32 v111, v189, v81, v83
    v_cvt_pk_bf16_f32 v94, v110, v111
    v_fma_f32 v110, v186, v80, v82
    v_fma_f32 v111, v190, v81, v83
    v_cvt_pk_bf16_f32 v96, v110, v111
    v_fma_f32 v110, v187, v80, v82
    v_fma_f32 v111, v191, v81, v83
    v_cvt_pk_bf16_f32 v98, v110, v111
    v_fma_f32 v110, v192, v80, v82
    v_fma_f32 v111, v196, v81, v83
    v_cvt_pk_bf16_f32 v100, v110, v111
    v_fma_f32 v110, v193, v80, v82
    v_fma_f32 v111, v197, v81, v83
    v_cvt_pk_bf16_f32 v102, v110, v111
    v_fma_f32 v110, v194, v80, v82
    v_fma_f32 v111, v198, v81, v83
    v_cvt_pk_bf16_f32 v104, v110, v111
    v_fma_f32 v110, v195, v80, v82
    v_fma_f32 v111, v199, v81, v83
    v_cvt_pk_bf16_f32 v106, v110, v111
    v_fma_f32 v110, v200, v84, v86
    v_fma_f32 v111, v204, v85, v87
    v_cvt_pk_bf16_f32 v93, v110, v111
    buffer_store_dwordx2 v[92:93], v246, s[28:31], s68 offen offset:256 sc1 nt
    v_fma_f32 v110, v201, v84, v86
    v_fma_f32 v111, v205, v85, v87
    v_cvt_pk_bf16_f32 v95, v110, v111
    buffer_store_dwordx2 v[94:95], v246, s[28:31], s69 offen offset:256 sc1 nt
    v_fma_f32 v110, v202, v84, v86
    v_fma_f32 v111, v206, v85, v87
    v_cvt_pk_bf16_f32 v97, v110, v111
    buffer_store_dwordx2 v[96:97], v246, s[28:31], s70 offen offset:256 sc1 nt
    v_fma_f32 v110, v203, v84, v86
    v_fma_f32 v111, v207, v85, v87
    v_cvt_pk_bf16_f32 v99, v110, v111
    buffer_store_dwordx2 v[98:99], v246, s[28:31], s71 offen offset:256 sc1 nt
    v_fma_f32 v110, v208, v84, v86
    v_fma_f32 v111, v212, v85, v87
    v_cvt_pk_bf16_f32 v101, v110, v111
    buffer_store_dwordx2 v[100:101], v246, s[28:31], s72 offen offset:256 sc1 nt
    v_fma_f32 v110, v209, v84, v86
    v_fma_f32 v111, v213, v85, v87
    v_cvt_pk_bf16_f32 v103, v110, v111
    buffer_store_dwordx2 v[102:103], v246, s[28:31], s73 offen offset:256 sc1 nt
    v_fma_f32 v110, v210, v84, v86
    v_fma_f32 v111, v214, v85, v87
    v_cvt_pk_bf16_f32 v105, v110, v111
    buffer_store_dwordx2 v[104:105], v246, s[28:31], s74 offen offset:256 sc1 nt
    v_fma_f32 v110, v211, v84, v86
    v_fma_f32 v111, v215, v85, v87
    v_cvt_pk_bf16_f32 v107, v110, v111
    buffer_store_dwordx2 v[106:107], v246, s[28:31], s75 offen offset:256 sc1 nt
    s_waitcnt vmcnt(0)
    v_fma_f32 v110, v216, v88, v90
    v_fma_f32 v111, v220, v89, v91
    v_cvt_pk_bf16_f32 v92, v110, v111
    buffer_store_dword v92, v247, s[28:31], s68 offen offset:0 sc1 nt
    v_fma_f32 v110, v217, v88, v90
    v_fma_f32 v111, v221, v89, v91
    v_cvt_pk_bf16_f32 v94, v110, v111
    buffer_store_dword v94, v247, s[28:31], s69 offen offset:0 sc1 nt
    v_fma_f32 v110, v218, v88, v90
    v_fma_f32 v111, v222, v89, v91
    v_cvt_pk_bf16_f32 v96, v110, v111
    buffer_store_dword v96, v247, s[28:31], s70 offen offset:0 sc1 nt
    v_fma_f32 v110, v219, v88, v90
    v_fma_f32 v111, v223, v89, v91
    v_cvt_pk_bf16_f32 v98, v110, v111
    buffer_store_dword v98, v247, s[28:31], s71 offen offset:0 sc1 nt
    v_fma_f32 v110, v224, v88, v90
    v_fma_f32 v111, v228, v89, v91
    v_cvt_pk_bf16_f32 v100, v110, v111
    buffer_store_dword v100, v247, s[28:31], s72 offen offset:0 sc1 nt
    v_fma_f32 v110, v225, v88, v90
    v_fma_f32 v111, v229, v89, v91
    v_cvt_pk_bf16_f32 v102, v110, v111
    buffer_store_dword v102, v247, s[28:31], s73 offen offset:0 sc1 nt
    v_fma_f32 v110, v226, v88, v90
    v_fma_f32 v111, v230, v89, v91
    v_cvt_pk_bf16_f32 v104, v110, v111
    buffer_store_dword v104, v247, s[28:31], s74 offen offset:0 sc1 nt
    v_fma_f32 v110, v227, v88, v90
    v_fma_f32 v111, v231, v89, v91
    v_cvt_pk_bf16_f32 v106, v110, v111
    buffer_store_dword v106, v247, s[28:31], s75 offen offset:0 sc1 nt
    s_endpgm
    .fill 256, 4, 0xbf800000
.section .rodata,"a"
.p2align 6
.amdhsa_kernel standalone__w8a8_smoothquant_per_tensor_per_channel_int8_activations_weights__prompt_kernel
  .amdhsa_next_free_vgpr 416
  .amdhsa_next_free_sgpr 102
  .amdhsa_accum_offset 256
  .amdhsa_group_segment_fixed_size 0
  .amdhsa_kernarg_size 72
  .amdhsa_user_sgpr_count 2
  .amdhsa_user_sgpr_kernarg_segment_ptr 1
  .amdhsa_system_sgpr_workgroup_id_x 1
.end_amdhsa_kernel
```
